```python
import torch

def _softmax(x, axis=-1):
    return torch.softmax(x, dim=axis)
def _gelu(x):
    return torch.nn.functional.gelu(x, approximate="tanh")
def _silu(x):
    return torch.nn.functional.silu(x)
def _sigmoid(x):
    return torch.sigmoid(x)
def _layernorm(x, axis=-1, eps=1e-5):
    m = x.mean(dim=axis, keepdim=True)
    v = x.var(dim=axis, keepdim=True, unbiased=False)
    return (x - m) / torch.sqrt(v + eps)
def _scatter_add(tgt, idx, src, axis=0):
    return tgt.clone().index_add_(axis, idx, src)
def _segment_sum(src, seg, n):
    out = torch.zeros((n,) + src.shape[1:], dtype=src.dtype)
    return out.index_add_(0, seg, src)
def _pad(x, pw):
    flat = tuple(v for pair in reversed(pw) for v in pair)
    return torch.nn.functional.pad(x, flat)

kernel_name = 'gated_mix__ssm_conv_s4__spectral_gfnet__prompt'

def setup_inputs():

    _w = (lambda a: (lambda t: t.to(torch.bfloat16) if t.is_floating_point() else t)(torch.as_tensor(a)))
    def _A_setup():
        B, L, D, N = 1, 2048, 512, 128
        A_re = -(lambda _x: torch.exp(torch.as_tensor(_x)))((lambda *s: torch.randn(*s, dtype=torch.bfloat16) * 3.2)(D, N))
        A_im = torch.pi * (lambda *s: torch.randn(*s, dtype=torch.bfloat16) * 0.05)(D, N)
        B_re = (lambda *s: torch.randn(*s, dtype=torch.bfloat16) * 0.1)(D, N)
        B_im = (lambda *s: torch.randn(*s, dtype=torch.bfloat16) * 0.1)(D, N)
        C_re = (lambda *s: torch.randn(*s, dtype=torch.bfloat16) * 0.1)(D, N)
        C_im = (lambda *s: torch.randn(*s, dtype=torch.bfloat16) * 0.1)(D, N)
        log_dt = (lambda *s: torch.randn(*s, dtype=torch.bfloat16) * 0.05)(D) * 0.5 - 4.0
        Dskip = (lambda *s: torch.randn(*s, dtype=torch.bfloat16) * 0.05)(D)
        return {
            "u": _w((lambda *s: torch.randn(*s, dtype=torch.bfloat16) * 0.05)(B, L, D)),
            "A_re": _w(A_re),
            "A_im": _w(A_im),
            "B_re": _w(B_re),
            "B_im": _w(B_im),
            "C_re": _w(C_re),
            "C_im": _w(C_im),
            "log_dt": _w(log_dt),
            "Dskip": _w(Dskip),
        }
    _A_in = _A_setup()

    def _B_setup():
        B, S, D = 1, 2048, 512
        Df = D // 2 + 1
        return {
            "x": _w((lambda *s: torch.randn(*s, dtype=torch.bfloat16) * 0.05)(B, S, D)),
            "w_r": _w((lambda *s: torch.randn(*s, dtype=torch.bfloat16) * 0.8)(S, Df) * 0.02),
            "w_i": _w((lambda *s: torch.randn(*s, dtype=torch.bfloat16) * 0.8)(S, Df) * 0.02),
        }
    _B_in = _B_setup()

    return {
        "A_u": _A_in["u"],
        "A_A_re": _A_in["A_re"],
        "A_A_im": _A_in["A_im"],
        "A_B_re": _A_in["B_re"],
        "A_B_im": _A_in["B_im"],
        "A_C_re": _A_in["C_re"],
        "A_C_im": _A_in["C_im"],
        "A_log_dt": _A_in["log_dt"],
        "A_Dskip": _A_in["Dskip"],
        "B_x": _B_in["x"],
        "B_w_r": _B_in["w_r"],
        "B_w_i": _B_in["w_i"],
        "gate_w": _w((lambda *s: torch.randn(*s, dtype=torch.bfloat16) * 0.05)(512) * 16.0),
    }

def reference(A_u, A_A_re, A_A_im, A_B_re, A_B_im, A_C_re, A_C_im, A_log_dt, A_Dskip, B_x, B_w_r, B_w_i, gate_w):
    def _A_ref(u, A_re, A_im, B_re, B_im, C_re, C_im, log_dt, Dskip):
        Bsz, L, D = u.shape
        dt = torch.exp(log_dt)[:, None]
        A = A_re + 1j * A_im
        Bc = B_re + 1j * B_im
        Cc = C_re + 1j * C_im
        logdA = dt * A
        dB = dt * Bc
        l = (lambda x, dt: x.to(dt))(torch.arange(L), A_re.dtype)
        P = torch.exp(logdA[:, :, None] * l[None, None, :])
        K = torch.einsum("dn,dnl,dn->dl", Cc, P, dB).real
        L2 = 2 * L
        Kp = _pad(K, ((0, 0), (0, L)))
        up = (lambda x, *d: x.permute(*d))(u, 0, 2, 1)
        up = _pad(up, ((0, 0), (0, 0), (0, L)))
        Kf = (lambda x, axes=(-2,-1): torch.fft.rfft2(x.float(), dim=axes))(Kp[:, None, :], axes=(-2, -1))
        Uf = (lambda x, axes=(-2,-1): torch.fft.rfft2(x.float(), dim=axes))(up[:, :, None, :], axes=(-2, -1))
        Yf = Uf * Kf[None, :, :, :]
        y = (lambda x, s, axes=(-2,-1): torch.fft.irfft2(x, s=s, dim=axes).to(torch.bfloat16))(Yf, (1, L2), axes=(-2, -1))[:, :, 0, :L]
        y = (lambda x, *d: x.permute(*d))(y, 0, 2, 1) + u * Dskip[None, None, :]
        return y

    def _B_ref(x, w_r, w_i):
        B, S, D = x.shape
        X = (lambda x, axes=(-2,-1): torch.fft.rfft2(x.float(), dim=axes))(x, axes=(-2, -1))
        W = w_r + 1j * w_i
        X = X * W
        y = (lambda x, s, axes=(-2,-1): torch.fft.irfft2(x, s=s, dim=axes).to(torch.bfloat16))(X, (S, D), axes=(-2, -1))
        return y

    x = A_u
    g = _sigmoid((x * gate_w).sum(-1, keepdims=True))
    a = _A_ref(x, A_A_re, A_A_im, A_B_re, A_B_im, A_C_re, A_C_im, A_log_dt, A_Dskip)
    b = _B_ref(x, B_w_r, B_w_i)
    return g * a + (1 - g) * b
```

```asm
; @launch grid=(512,1,1) block=(256,1,1) lds=80640
.amdgcn_target "amdgcn-amd-amdhsa--gfx950"
.text
.globl gated_mix__ssm_conv_s4__spectral_gfnet__prompt_kernel
.p2align 8
.type gated_mix__ssm_conv_s4__spectral_gfnet__prompt_kernel,@function
gated_mix__ssm_conv_s4__spectral_gfnet__prompt_kernel:
L_codestart:
    s_cmp_ge_u32 s2, 512
    s_cbranch_scc1 L_end
    s_getpc_b64 s[14:15]
L_pc0:
    v_lshlrev_b32_e64 v255, 7, v0
    v_min_u32 v255, L_codeend-L_pc0-4, v255
    global_load_dword v255, v255, s[14:15]
    v_lshrrev_b32_e64 v1, 6, v0
    s_and_b32 s9, s2, 7
    v_readfirstlane_b32 s10, v1
    s_bfe_u32 s12, s2, 0x50003
    s_lshl_b32 s8, s9, 5
    s_add_u32 s8, s8, s12
    s_cmp_ge_u32 s2, 256
    s_cbranch_scc1 L_conv
    s_load_dwordx2 s[18:19], s[0:1], 0
    s_load_dwordx16 s[20:35], s[0:1], 64
    s_setprio 3
    s_lshl_b32 s11, s8, 10
    v_lshlrev_b32 v20, 2, v0
    v_add_u32_e64 v10, s11, v20
    v_add_u32 v11, 262144, v10
    v_add_u32 v12, 524288, v10
    v_add_u32 v13, 786432, v10
    v_add_u32 v14, 1048576, v10
    v_add_u32 v15, 1310720, v10
    v_add_u32 v16, 1572864, v10
    v_add_u32 v17, 1835008, v10
    s_waitcnt lgkmcnt(0)
    s_nop 0
    global_load_dword v2, v10, s[18:19]
    global_load_dword v6, v14, s[18:19]
    global_load_dword v4, v12, s[18:19]
    global_load_dword v8, v16, s[18:19]
    global_load_dword v3, v11, s[18:19]
    global_load_dword v7, v15, s[18:19]
    global_load_dword v5, v13, s[18:19]
    global_load_dword v9, v17, s[18:19]
    v_mov_b32_e64 v18, 0
    global_load_dword v18, v18, s[34:35]
    v_and_b32_e64 v38, 15, v0
    v_bfe_u32 v39, v0, 4, 2
    v_and_b32 v40, 63, v0
    v_cvt_f32_u32 v43, v38
    v_cvt_f32_u32 v44, v39
    v_lshlrev_b32 v40, 4, v40
    v_mul_f32_e64 v44, 4.0, v44
    s_bitcmp1_b32 s10, 1
    s_cbranch_scc1 L_ja23
    s_bitcmp1_b32 s10, 0
    s_cbranch_scc1 L_ja1
    v_mul_f32 v45, 0x3d000000, v43
    v_mul_f32 v48, v45, v44
    v_add_f32 v49, v45, v48
    v_fmamk_f32 v50, v45, 0x40000000, v48
    v_fmamk_f32 v51, v45, 0x40400000, v48
    v_fmamk_f32 v52, v45, 0x41800000, v48
    v_fmamk_f32 v53, v45, 0x41880000, v48
    v_fmamk_f32 v54, v45, 0x41900000, v48
    v_fmamk_f32 v55, v45, 0x41980000, v48
    v_cos_f32 v56, v48
    v_sin_f32 v64, v48
    v_cos_f32 v57, v49
    v_sin_f32 v65, v49
    v_cos_f32 v58, v50
    v_sin_f32 v66, v50
    v_cos_f32 v59, v51
    v_sin_f32 v67, v51
    v_cos_f32 v60, v52
    v_sin_f32 v68, v52
    v_cos_f32 v61, v53
    v_sin_f32 v69, v53
    v_cos_f32 v62, v54
    v_sin_f32 v70, v54
    v_cos_f32 v63, v55
    v_sin_f32 v71, v55
    v_cvt_pk_bf16_f32 v72, v56, v57
    v_cvt_pk_bf16_f32 v73, v58, v59
    v_cvt_pk_bf16_f32 v74, v60, v61
    v_cvt_pk_bf16_f32 v75, v62, v63
    v_cvt_pk_bf16_f32 v76, -v64, -v65
    v_cvt_pk_bf16_f32 v77, -v66, -v67
    v_cvt_pk_bf16_f32 v78, -v68, -v69
    v_cvt_pk_bf16_f32 v79, -v70, -v71
    ds_write_b128 v40, v[72:75] offset:19456
    ds_write_b128 v40, v[76:79] offset:21504
    v_xor_b32 v80, 0x80000000, v72
    v_xor_b32 v84, 0x80000000, v76
    v_xor_b32 v81, 0x80000000, v73
    v_xor_b32 v85, 0x80000000, v77
    v_xor_b32 v82, 0x80000000, v74
    v_xor_b32 v86, 0x80000000, v78
    v_xor_b32 v83, 0x80000000, v75
    v_xor_b32 v87, 0x80000000, v79
    ds_write_b128 v40, v[80:83] offset:20480
    ds_write_b128 v40, v[84:87] offset:22528
    s_branch L_jad
L_ja1:
    v_mul_f32 v45, 0x3b000000, v43
    v_mul_f32 v48, v45, v44
    v_add_f32_e64 v49, v45, v48
    v_fmamk_f32 v50, v45, 0x40000000, v48
    v_fmamk_f32 v51, v45, 0x40400000, v48
    v_add_f32 v45, 0x3d000000, v45
    v_mul_f32 v52, v45, v44
    v_add_f32 v53, v45, v52
    v_fmamk_f32 v54, v45, 0x40000000, v52
    v_fmamk_f32 v55, v45, 0x40400000, v52
    v_cos_f32 v56, v48
    v_sin_f32 v64, v48
    v_cos_f32 v57, v49
    v_sin_f32 v65, v49
    v_cos_f32 v58, v50
    v_sin_f32 v66, v50
    v_cos_f32 v59, v51
    v_sin_f32 v67, v51
    v_cos_f32 v60, v52
    v_sin_f32 v68, v52
    v_cos_f32 v61, v53
    v_sin_f32 v69, v53
    v_cos_f32 v62, v54
    v_sin_f32 v70, v54
    v_cos_f32 v63, v55
    v_sin_f32 v71, v55
    ds_write_b128 v40, v[56:59] offset:23552
    ds_write_b128 v40, v[60:63] offset:24576
    ds_write_b128 v40, v[64:67] offset:25600
    ds_write_b128 v40, v[68:71] offset:26624
    s_branch L_jad
L_ja23:
    s_bitcmp1_b32 s10, 0
    s_cbranch_scc1 L_ja3
    v_lshrrev_b32 v45, 1, v38
    v_and_b32 v46, 1, v38
    v_cvt_f32_u32 v45, v45
    v_cvt_f32_u32_e64 v46, v46
    v_mul_f32 v45, 0x3d800000, v45
    v_mul_f32 v48, 0x3e800000, v46
    v_fmac_f32 v48, v45, v44
    v_add_f32 v49, v45, v48
    v_fmamk_f32 v50, v45, 0x40000000, v48
    v_fmamk_f32 v51, v45, 0x40400000, v48
    v_cos_f32 v56, v48
    v_sin_f32 v64, v48
    v_cos_f32 v57, v49
    v_sin_f32 v65, v49
    v_cos_f32 v58, v50
    v_sin_f32 v66, v50
    v_cos_f32 v59, v51
    v_sin_f32 v67, v51
    v_cvt_pk_bf16_f32 v72, v56, v64
    v_cvt_pk_bf16_f32 v73, v57, v65
    v_cvt_pk_bf16_f32 v74, v58, v66
    v_cvt_pk_bf16_f32 v75, v59, v67
    v_cvt_pk_bf16_f32 v76, v64, -v56
    v_cvt_pk_bf16_f32 v77, v65, -v57
    v_cvt_pk_bf16_f32 v78, v66, -v58
    v_cvt_pk_bf16_f32 v79, v67, -v59
    v_cvt_pk_bf16_f32 v80, -v64, v56
    v_cvt_pk_bf16_f32 v81, -v65, v57
    v_cvt_pk_bf16_f32 v82, -v66, v58
    v_cvt_pk_bf16_f32 v83, -v67, v59
    ds_write_b128 v40, v[72:75] offset:27648
    ds_write_b128 v40, v[76:79] offset:28672
    ds_write_b128 v40, v[72:75] offset:29696
    ds_write_b128 v40, v[80:83] offset:30720
    ds_write_b128 v40, v[72:75] offset:33792
    ds_write_b128 v40, v[72:75] offset:36864
    s_branch L_jad
L_ja3:
    v_add_u32 v46, v38, v38
    s_movk_i32 s11, 17
    v_bfe_i32 v56, s11, v46, 2
    v_cvt_f32_i32 v56, v56
    s_movk_i32 s11, 196
    v_bfe_i32 v57, s11, v46, 2
    v_cvt_f32_i32 v57, v57
    s_movk_i32 s11, 1
    v_bfe_i32 v58, s11, v46, 2
    v_cvt_f32_i32 v58, v58
    s_movk_i32 s11, 16
    v_bfe_i32 v59, s11, v46, 2
    v_cvt_f32_i32 v59, v59
    v_mov_b32 v48, 0
    v_mov_b32 v49, 0
    v_mov_b32 v50, 0
    v_mov_b32 v51, 0
    ds_write_b128 v40, v[48:51] offset:34816
    ds_write_b128 v40, v[48:51] offset:35840
    v_lshrrev_b32 v72, 16, v56
    v_lshrrev_b32 v74, 16, v56
    v_xor_b32 v73, 0x8000, v72
    v_xor_b32 v75, 0x8000, v72
    ds_write_b128 v40, v[72:75] offset:31744
    v_lshrrev_b32 v76, 16, v57
    v_lshrrev_b32 v78, 16, v57
    v_xor_b32 v77, 0x8000, v76
    v_xor_b32 v79, 0x8000, v76
    ds_write_b128 v40, v[76:79] offset:32768
    v_lshrrev_b32 v80, 16, v58
    v_lshrrev_b32 v82, 16, v58
    v_xor_b32 v81, 0x8000, v80
    v_xor_b32 v83, 0x8000, v80
    ds_write_b128 v40, v[80:83] offset:37888
    v_lshrrev_b32 v84, 16, v59
    v_lshrrev_b32 v86, 16, v59
    v_xor_b32 v85, 0x8000, v84
    v_xor_b32 v87, 0x8000, v84
    ds_write_b128 v40, v[84:87] offset:38912
L_jad:
    s_waitcnt lgkmcnt(0)
    s_barrier
    s_cmp_eq_u32 s10, 0
    s_cselect_b32 s11, 6144, 0
    v_add_u32 v41, s11, v40
    ds_read_b128 v[88:91], v40 offset:19456
    ds_read_b128 v[96:99], v40 offset:21504
    ds_read_b128 v[92:95], v40 offset:20480
    ds_read_b128 v[100:103], v40 offset:22528
    ds_read_b128 v[104:107], v40 offset:23552
    ds_read_b128 v[112:115], v40 offset:25600
    ds_read_b128 v[108:111], v40 offset:24576
    ds_read_b128 v[116:119], v40 offset:26624
    ds_read_b128 v[120:123], v41 offset:27648
    ds_read_b128 v[124:127], v41 offset:28672
    ds_read_b128 v[128:131], v41 offset:29696
    ds_read_b128 v[132:135], v41 offset:30720
    ds_read_b128 v[136:139], v41 offset:31744
    ds_read_b128 v[140:143], v41 offset:32768
    s_lshr_b32 s17, s2, 3
    s_lshr_b32 s44, s9, 1
    s_sub_u32 s11, 0, s44
    s_cmp_eq_u32 s9, 1
    s_cselect_b32 s11, 4, s11
    s_bitcmp1_b32 s9, 0
    s_cselect_b32 s44, s11, s44
    s_mov_b64 s[36:37], s[24:25]
    s_mov_b32 s38, 1052672
    s_mov_b32 s39, 0x20000
    s_mov_b64 s[40:41], s[26:27]
    s_mov_b32 s42, 1052672
    s_mov_b32 s43, 0x20000
    global_load_dword v19, v20, s[28:29]
    s_cmp_lg_u32 s10, 3
    s_cbranch_scc1 L_nwp
    v_bfe_u32 v41, v0, 3, 3
    s_lshl_b32 s11, s17, 6
    s_add_u32 s11, s11, s44
    v_lshl_add_u32 v41, v41, 3, s11
    v_and_b32 v41, 2047, v41
    v_mul_u32_u24 v41, 514, v41
    v_and_b32 v42, 7, v0
    v_min_u32_e64 v42, 4, v42
    v_lshl_add_u32 v41, v42, 7, v41
    v_and_b32_e64 v41, -4, v41
    buffer_load_dword v22, v41, s[36:39], 0 offen
    buffer_load_dword v30, v41, s[40:43], 0 offen
L_nwp:
    s_mov_b32 s46, 0x3f3504f3
    s_lshl_b32 s11, s10, 11
    v_lshrrev_b32 v149, 1, v40
    v_add_u32 v149, s11, v149
    s_waitcnt vmcnt(9)
    v_lshlrev_b32_e64 v164, 16, v2
    v_and_b32 v165, 0xffff0000, v2
    s_waitcnt vmcnt(8)
    v_lshlrev_b32 v172, 16, v6
    v_and_b32 v173, 0xffff0000, v6
    v_pk_add_f32 v[180:181], v[164:165], v[172:173]
    v_pk_add_f32 v[188:189], v[164:165], v[172:173] neg_lo:[0,1] neg_hi:[0,1]
    s_waitcnt vmcnt(7)
    v_lshlrev_b32 v168, 16, v4
    v_and_b32 v169, 0xffff0000, v4
    s_waitcnt vmcnt(6)
    v_lshlrev_b32 v176, 16, v8
    v_and_b32 v177, 0xffff0000, v8
    v_pk_add_f32 v[184:185], v[168:169], v[176:177]
    v_pk_add_f32 v[192:193], v[168:169], v[176:177] neg_lo:[0,1] neg_hi:[0,1]
    s_waitcnt vmcnt(5)
    v_lshlrev_b32 v166, 16, v3
    v_and_b32 v167, 0xffff0000, v3
    s_waitcnt vmcnt(4)
    v_lshlrev_b32 v174, 16, v7
    v_and_b32 v175, 0xffff0000, v7
    v_pk_add_f32 v[182:183], v[166:167], v[174:175]
    v_pk_add_f32 v[190:191], v[166:167], v[174:175] neg_lo:[0,1] neg_hi:[0,1]
    s_waitcnt vmcnt(3)
    v_lshlrev_b32 v170, 16, v5
    v_and_b32 v171, 0xffff0000, v5
    s_waitcnt vmcnt(2)
    v_lshlrev_b32 v178, 16, v9
    v_and_b32 v179, 0xffff0000, v9
    v_pk_add_f32 v[186:187], v[170:171], v[178:179]
    v_pk_add_f32 v[194:195], v[170:171], v[178:179] neg_lo:[0,1] neg_hi:[0,1]
    v_pk_add_f32 v[168:169], v[180:181], v[184:185] neg_lo:[0,1] neg_hi:[0,1]
    v_pk_add_f32 v[170:171], v[186:187], v[182:183] neg_lo:[0,1] neg_hi:[0,1]
    v_pk_add_f32 v[164:165], v[180:181], v[184:185]
    v_pk_add_f32 v[166:167], v[182:183], v[186:187]
    v_cvt_pk_bf16_f32 v200, v168, v169
    ds_write_b32 v20, v200 offset:4096
    v_pk_add_f32 v[172:173], v[190:191], v[194:195] neg_lo:[0,1] neg_hi:[0,1]
    v_pk_add_f32 v[174:175], v[190:191], v[194:195]
    v_cvt_pk_bf16_f32 v201, v170, v171
    ds_write_b32 v20, v201 offset:5120
    v_pk_add_f32 v[176:177], v[164:165], v[166:167]
    v_pk_add_f32 v[178:179], v[164:165], v[166:167] neg_lo:[0,1] neg_hi:[0,1]
    v_pk_fma_f32 v[180:181], v[172:173], s[46:47], v[188:189] op_sel_hi:[1,0,1]
    v_pk_fma_f32 v[182:183], v[174:175], s[46:47], v[192:193] op_sel_hi:[1,0,1] neg_lo:[1,0,1] neg_hi:[1,0,1]
    v_pk_fma_f32 v[184:185], v[172:173], s[46:47], v[188:189] op_sel_hi:[1,0,1] neg_lo:[1,0,0] neg_hi:[1,0,0]
    v_pk_fma_f32 v[186:187], v[174:175], s[46:47], v[192:193] op_sel_hi:[1,0,1] neg_lo:[1,0,0] neg_hi:[1,0,0]
    v_cvt_pk_bf16_f32 v196, v176, v177
    ds_write_b32 v20, v196 offset:0
    v_cvt_pk_bf16_f32 v197, v178, v179
    ds_write_b32 v20, v197 offset:1024
    v_cvt_pk_bf16_f32 v198, v180, v181
    ds_write_b32 v20, v198 offset:2048
    v_cvt_pk_bf16_f32 v199, v182, v183
    ds_write_b32 v20, v199 offset:3072
    v_cvt_pk_bf16_f32 v202, v184, v185
    ds_write_b32 v20, v202 offset:6144
    v_cvt_pk_bf16_f32 v203, v186, v187
    ds_write_b32 v20, v203 offset:7168
    s_waitcnt lgkmcnt(0)
    s_barrier
    ds_read_b64_tr_b16 v[164:165], v149 offset:0
    ds_read_b64_tr_b16 v[166:167], v149 offset:512
    ds_read_b64_tr_b16 v[168:169], v149 offset:1024
    ds_read_b64_tr_b16 v[170:171], v149 offset:1536
    s_mul_i32 s11, s10, 2816
    s_add_u32 s11, s11, 8192
    v_lshl_add_u32 v41, v39, 6, v38
    v_mul_u32_u24 v144, 171, v41
    v_lshrrev_b32 v144, 9, v144
    v_add_u32 v46, v41, v144
    v_lshl_add_u32 v144, v46, 2, s11
    v_add_u32_e64 v41, 16, v41
    v_mul_u32_u24 v145, 171, v41
    v_lshrrev_b32 v145, 9, v145
    v_add_u32 v46, v41, v145
    v_lshl_add_u32 v145, v46, 2, s11
    s_waitcnt lgkmcnt(2)
    v_mfma_f32_16x16x32_bf16 v[172:175], v[164:167], v[88:91], 0
    v_mfma_f32_16x16x32_bf16 v[188:191], v[164:167], v[96:99], 0
    v_mfma_f32_16x16x32_bf16 v[176:179], v[164:167], v[92:95], 0
    v_mfma_f32_16x16x32_bf16 v[192:195], v[164:167], v[100:103], 0
    v_add_u32 v41, 16, v41
    v_mul_u32_u24 v146, 171, v41
    v_lshrrev_b32 v146, 9, v146
    v_add_u32 v46, v41, v146
    v_lshl_add_u32 v146, v46, 2, s11
    v_add_u32_e64 v41, 16, v41
    v_mul_u32_u24 v147, 171, v41
    v_lshrrev_b32 v147, 9, v147
    v_add_u32 v46, v41, v147
    v_lshl_add_u32 v147, v46, 2, s11
    s_waitcnt lgkmcnt(0)
    v_mfma_f32_16x16x32_bf16 v[180:183], v[168:171], v[88:91], 0
    v_mfma_f32_16x16x32_bf16 v[196:199], v[168:171], v[96:99], 0
    v_mfma_f32_16x16x32_bf16 v[184:187], v[168:171], v[92:95], 0
    v_mfma_f32_16x16x32_bf16 v[200:203], v[168:171], v[100:103], 0
    v_min_u32 v148, 4, v40
    v_add_u32 v148, s11, v148
    v_mul_f32 v205, v172, v104
    v_mul_f32 v209, v188, v104
    v_mul_f32 v206, v173, v105
    v_mul_f32 v210, v189, v105
    v_mul_f32 v207, v174, v106
    v_mul_f32 v211, v190, v106
    v_mul_f32 v208, v175, v107
    v_mul_f32 v212, v191, v107
    v_fmac_f32 v205, v188, v112
    v_fmac_f32 v206, v189, v113
    v_fmac_f32 v207, v190, v114
    v_fmac_f32_e64 v208, v191, v115
    v_fma_f32 v209, -v172, v112, v209
    v_fma_f32 v210, -v173, v113, v210
    v_fma_f32 v211, -v174, v114, v211
    v_fma_f32 v212, -v175, v115, v212
    v_cvt_pk_bf16_f32 v214, v205, v209
    v_cvt_pk_bf16_f32 v215, v206, v210
    v_cvt_pk_bf16_f32 v216, v207, v211
    v_cvt_pk_bf16_f32 v217, v208, v212
    v_mul_f32 v205, v176, v108
    v_mul_f32 v209, v192, v108
    v_mfma_f32_16x16x32_bf16 v[222:225], v[120:123], v[214:217], 0
    v_mfma_f32_16x16x32_bf16 v[230:233], v[128:131], v[214:217], 0
    v_mfma_f32_16x16x32_bf16 v[238:241], v[136:139], v[214:217], 0
    v_mul_f32 v206, v177, v109
    v_mul_f32 v210, v193, v109
    v_mul_f32 v207, v178, v110
    v_mul_f32 v211, v194, v110
    v_mul_f32 v208, v179, v111
    v_mul_f32 v212, v195, v111
    v_fmac_f32 v205, v192, v116
    v_fmac_f32 v206, v193, v117
    v_fmac_f32 v207, v194, v118
    v_fmac_f32 v208, v195, v119
    v_fma_f32 v209, -v176, v116, v209
    v_fma_f32 v210, -v177, v117, v210
    v_fma_f32 v211, -v178, v118, v211
    v_fma_f32 v212, -v179, v119, v212
    v_cvt_pk_bf16_f32 v218, v205, v209
    v_cvt_pk_bf16_f32 v219, v206, v210
    v_cvt_pk_bf16_f32 v220, v207, v211
    v_cvt_pk_bf16_f32 v221, v208, v212
    v_mul_f32 v205, v180, v104
    v_mul_f32 v209, v196, v104
    v_mfma_f32_16x16x32_bf16 v[226:229], v[120:123], v[218:221], 0
    v_mfma_f32_16x16x32_bf16 v[234:237], v[128:131], v[218:221], 0
    v_mul_f32 v206, v181, v105
    v_mul_f32 v210, v197, v105
    v_mul_f32 v207, v182, v106
    v_mul_f32 v211, v198, v106
    v_mul_f32 v208, v183, v107
    v_mul_f32 v212, v199, v107
    v_fmac_f32 v205, v196, v112
    v_fmac_f32 v206, v197, v113
    v_fmac_f32 v207, v198, v114
    v_fmac_f32 v208, v199, v115
    v_fma_f32 v209, -v180, v112, v209
    v_fma_f32 v210, -v181, v113, v210
    v_fma_f32 v211, -v182, v114, v211
    v_fma_f32 v212, -v183, v115, v212
    v_cvt_pk_bf16_f32 v214, v205, v209
    v_cvt_pk_bf16_f32 v215, v206, v210
    v_cvt_pk_bf16_f32 v216, v207, v211
    v_cvt_pk_bf16_f32 v217, v208, v212
    v_mul_f32 v205, v184, v108
    v_mul_f32 v209, v200, v108
    v_mfma_f32_16x16x32_bf16 v[222:225], v[124:127], v[214:217], v[222:225]
    v_mfma_f32_16x16x32_bf16 v[230:233], v[132:135], v[214:217], v[230:233]
    v_mfma_f32_16x16x32_bf16 v[238:241], v[140:143], v[214:217], v[238:241]
    v_mul_f32 v206, v185, v109
    v_mul_f32 v210, v201, v109
    v_mul_f32 v207, v186, v110
    v_mul_f32 v211, v202, v110
    v_mul_f32 v208, v187, v111
    v_mul_f32 v212, v203, v111
    v_fmac_f32 v205, v200, v116
    v_fmac_f32 v206, v201, v117
    v_fmac_f32 v207, v202, v118
    v_fmac_f32 v208, v203, v119
    v_fma_f32 v209, -v184, v116, v209
    v_fma_f32 v210, -v185, v117, v210
    v_fma_f32 v211, -v186, v118, v211
    v_fma_f32 v212, -v187, v119, v212
    v_cvt_pk_bf16_f32 v218, v205, v209
    v_cvt_pk_bf16_f32 v219, v206, v210
    v_cvt_pk_bf16_f32 v220, v207, v211
    v_cvt_pk_bf16_f32 v221, v208, v212
    s_mov_b32 s12, 0x9E3779B1
    s_waitcnt vmcnt(1)
    v_mul_lo_u32 v18, v18, s12
    v_mfma_f32_16x16x32_bf16 v[226:229], v[124:127], v[218:221], v[226:229]
    v_mfma_f32_16x16x32_bf16 v[234:237], v[132:135], v[218:221], v[234:237]
    v_add_u32 v18, 0x7F4A7C15, v18
    v_lshlrev_b32 v150, 4, v0
    v_cvt_pk_bf16_f32 v242, v222, v223
    ds_write_b32 v144, v242 offset:0
    v_cvt_pk_bf16_f32 v243, v224, v225
    ds_write_b32 v146, v243 offset:0
    v_cvt_pk_bf16_f32 v244, v230, v231
    ds_write_b32 v144, v244 offset:1408
    v_cvt_pk_bf16_f32 v245, v232, v233
    ds_write_b32 v146, v245 offset:1408
    v_cvt_pk_bf16_f32 v250, v238, v239
    ds_write_b32 v148, v250 offset:1364
    v_cvt_pk_bf16_f32 v251, v240, v241
    ds_write_b32 v148, v251 offset:2772
    v_cvt_pk_bf16_f32 v246, v226, v227
    ds_write_b32 v145, v246 offset:0
    v_cvt_pk_bf16_f32 v247, v228, v229
    ds_write_b32 v147, v247 offset:0
    v_cvt_pk_bf16_f32 v248, v234, v235
    ds_write_b32 v145, v248 offset:1408
    v_cvt_pk_bf16_f32 v249, v236, v237
    ds_write_b32 v147, v249 offset:1408
    v_readfirstlane_b32 s3, v18
    v_mov_b32 v155, v18
    v_mov_b32 v159, v18
    v_mov_b32 v163, v18
    s_waitcnt lgkmcnt(0)
    s_barrier
    ds_read_b96 v[152:154], v150 offset:8192
    ds_read_b96 v[156:158], v150 offset:12288
    ds_read_b96 v[160:162], v150 offset:16384
    s_mov_b64 s[4:5], s[34:35]
    s_nop 0
    s_mov_b32 s6, 12582912
    s_mov_b32 s7, 0x20000
    s_mul_i32 s11, s8, 11392
    s_add_u32 s48, s11, 3211264
    s_add_u32 s49, s48, 4096
    s_add_u32 s50, s48, 8192
    s_cmp_eq_u32 s10, 3
    s_cmov_b32 s50, 0x40000000
    s_waitcnt lgkmcnt(2)
    buffer_store_dwordx4 v[152:155], v150, s[4:7], s48 offen sc1
    s_waitcnt lgkmcnt(1)
    buffer_store_dwordx4 v[156:159], v150, s[4:7], s49 offen sc1
    s_waitcnt lgkmcnt(0)
    buffer_store_dwordx4 v[160:163], v150, s[4:7], s50 offen sc1
    s_setprio 1
    v_cvt_f32_i32 v47, s44
    s_waitcnt vmcnt(3)
    s_cmp_ge_u32 s17, 22
    s_cbranch_scc1 L_p3
    v_lshrrev_b32_e64 v41, 1, v0
    v_lshl_add_u32 v21, v41, 3, s44
    v_add_u32 v42, 1024, v21
    v_and_b32 v21, 2047, v21
    v_mul_u32_u24 v21, 514, v21
    v_mul_u32_u24 v42, 514, v42
    v_and_b32 v178, 1, v0
    v_lshlrev_b32 v178, 4, v178
    v_and_b32 v21, -4, v21
    v_and_b32 v42, -4, v42
    v_add_u32_e64 v21, v21, v178
    v_add_u32 v42, v42, v178
    s_mul_i32 s11, s17, 24
    buffer_load_dwordx4 v[22:25], v21, s[36:39], s11 offen
    buffer_load_dwordx4 v[30:33], v21, s[40:43], s11 offen
    buffer_load_dwordx4 v[26:29], v42, s[36:39], s11 offen
    buffer_load_dwordx4 v[34:37], v42, s[40:43], s11 offen
    v_mad_u32_u24 v21, v41, 48, v178
    s_bitcmp1_b32 s10, 1
    s_cbranch_scc1 L_jb23
    s_bitcmp1_b32 s10, 0
    s_cbranch_scc1 L_jb1
    v_fmamk_f32 v45, v43, 0x41000000, v47
    v_mul_f32 v45, 0x3c000000, v45
    v_mul_f32 v48, v45, v44
    v_add_f32 v49, v45, v48
    v_fmamk_f32 v50, v45, 0x40000000, v48
    v_fmamk_f32 v51, v45, 0x40400000, v48
    v_mul_f32 v52, 0x3d800000, v48
    v_mul_f32 v53, 0x3d800000, v49
    v_mul_f32 v54, 0x3d800000, v50
    v_mul_f32 v55, 0x3d800000, v51
    v_cos_f32 v56, v48
    v_sin_f32 v64, v48
    v_cos_f32 v57, v49
    v_sin_f32 v65, v49
    v_cos_f32 v58, v50
    v_sin_f32 v66, v50
    v_cos_f32 v59, v51
    v_sin_f32 v67, v51
    v_cos_f32 v60, v52
    v_sin_f32 v68, v52
    v_cos_f32 v61, v53
    v_sin_f32 v69, v53
    v_cos_f32 v62, v54
    v_sin_f32 v70, v54
    v_cos_f32 v63, v55
    v_sin_f32 v71, v55
    v_cvt_pk_bf16_f32 v72, v56, v64
    v_cvt_pk_bf16_f32 v73, v57, v65
    v_cvt_pk_bf16_f32 v74, v58, v66
    v_cvt_pk_bf16_f32 v75, v59, v67
    v_cvt_pk_bf16_f32 v76, -v64, v56
    v_cvt_pk_bf16_f32 v77, -v65, v57
    v_cvt_pk_bf16_f32 v78, -v66, v58
    v_cvt_pk_bf16_f32 v79, -v67, v59
    ds_write_b128 v40, v[72:75] offset:52224
    ds_write_b128 v40, v[76:79] offset:53248
    ds_write_b128 v40, v[60:63] offset:60416
    ds_write_b128 v40, v[68:71] offset:61440
    s_branch L_jbd
L_jb1:
    v_mul_f32 v45, 0x3d800000, v43
    v_mul_f32 v48, v45, v44
    v_add_f32_e64 v49, v45, v48
    v_fmamk_f32 v50, v45, 0x40000000, v48
    v_fmamk_f32 v51, v45, 0x40400000, v48
    v_cos_f32 v56, v48
    v_sin_f32 v64, v48
    v_cos_f32 v57, v49
    v_sin_f32 v65, v49
    v_cos_f32 v58, v50
    v_sin_f32 v66, v50
    v_cos_f32 v59, v51
    v_sin_f32 v67, v51
    v_cvt_pk_bf16_f32 v72, v56, v64
    v_cvt_pk_bf16_f32 v73, v57, v65
    v_cvt_pk_bf16_f32 v74, v58, v66
    v_cvt_pk_bf16_f32 v75, v59, v67
    v_cvt_pk_bf16_f32 v76, -v64, v56
    v_cvt_pk_bf16_f32 v77, -v65, v57
    v_cvt_pk_bf16_f32 v78, -v66, v58
    v_cvt_pk_bf16_f32 v79, -v67, v59
    ds_write_b128 v40, v[72:75] offset:54272
    ds_write_b128 v40, v[76:79] offset:55296
    v_xor_b32 v80, 0x80000000, v72
    v_xor_b32 v84, 0x8000, v76
    v_xor_b32 v81, 0x80000000, v73
    v_xor_b32 v85, 0x8000, v77
    v_xor_b32 v82, 0x80000000, v74
    v_xor_b32 v86, 0x8000, v78
    v_xor_b32 v83, 0x80000000, v75
    v_xor_b32 v87, 0x8000, v79
    ds_write_b128 v40, v[80:83] offset:56320
    ds_write_b128 v40, v[84:87] offset:57344
    s_branch L_jbd
L_jb23:
    s_bitcmp1_b32 s10, 0
    s_cbranch_scc1 L_jb3
    v_fmamk_f32 v46, v44, 0x41000000, v47
    v_mul_f32 v45, 0x3d800000, v43
    v_mul_f32 v46, v46, v43
    v_mul_f32 v48, 0x3c000000, v46
    v_add_f32_e64 v49, v45, v48
    v_fmamk_f32 v50, v45, 0x40000000, v48
    v_fmamk_f32 v51, v45, 0x40400000, v48
    v_mul_f32 v52, 0x3d800000, v48
    v_mul_f32 v53, 0x3d800000, v49
    v_mul_f32 v54, 0x3d800000, v50
    v_mul_f32 v55, 0x3d800000, v51
    v_cos_f32 v56, v48
    v_sin_f32 v64, v48
    v_cos_f32 v57, v49
    v_sin_f32 v65, v49
    v_cos_f32 v58, v50
    v_sin_f32 v66, v50
    v_cos_f32 v59, v51
    v_sin_f32 v67, v51
    v_cos_f32 v60, v52
    v_sin_f32 v68, v52
    v_cos_f32 v61, v53
    v_sin_f32 v69, v53
    v_cos_f32 v62, v54
    v_sin_f32 v70, v54
    v_cos_f32 v63, v55
    v_sin_f32 v71, v55
    v_cvt_pk_bf16_f32 v72, v56, -v64
    v_cvt_pk_bf16_f32 v73, v57, -v65
    v_cvt_pk_bf16_f32 v74, v58, -v66
    v_cvt_pk_bf16_f32 v75, v59, -v67
    v_cvt_pk_bf16_f32 v76, v64, v56
    v_cvt_pk_bf16_f32 v77, v65, v57
    v_cvt_pk_bf16_f32 v78, v66, v58
    v_cvt_pk_bf16_f32 v79, v67, v59
    ds_write_b128 v40, v[72:75] offset:58368
    ds_write_b128 v40, v[76:79] offset:59392
    ds_write_b128 v40, v[60:63] offset:62464
    ds_write_b128 v40, v[68:71] offset:63488
    s_branch L_jbd
L_jb3:
L_jbd:
    v_bfe_u32 v41, v0, 2, 4
    v_mul_u32_u24 v148, 11392, v41
    v_and_b32 v41, 3, v0
    v_lshl_add_u32 v148, v41, 4, v148
    s_mul_i32 s11, s9, 22
    s_add_u32 s11, s11, s17
    s_mul_i32 s12, s10, 729088
    s_lshl_b32 s48, s11, 6
    s_add_u32 s48, s48, s12
    s_add_u32 s48, s48, 3211264
    s_add_u32 s49, s48, 182272
    s_add_u32 s50, s48, 364544
    s_add_u32 s51, s48, 546816
    s_mul_i32 s16, s11, 16512
    s_add_u32 s16, s16, 6160384
    s_waitcnt vmcnt(4)
    buffer_load_dwordx4 v[180:183], v148, s[4:7], s48 offen sc1
    buffer_load_dwordx4 v[184:187], v148, s[4:7], s49 offen sc1
    buffer_load_dwordx4 v[188:191], v148, s[4:7], s50 offen sc1
    buffer_load_dwordx4 v[192:195], v148, s[4:7], s51 offen sc1
    s_waitcnt vmcnt(7)
    ds_write_b128 v21, v[22:25] offset:19456
    s_waitcnt vmcnt(6)
    ds_write_b128 v21, v[30:33] offset:31744
    s_waitcnt vmcnt(5)
    ds_write_b128 v21, v[26:29] offset:25600
    s_waitcnt vmcnt(4)
    ds_write_b128 v21, v[34:37] offset:37888
    s_waitcnt lgkmcnt(0)
    s_barrier
    s_nop 0
    ds_read_b128 v[88:91], v40 offset:52224
    ds_read_b128 v[92:95], v40 offset:53248
    ds_read_b128 v[120:123], v40 offset:60416
    ds_read_b128 v[124:127], v40 offset:61440
    ds_read_b128 v[96:99], v40 offset:54272
    ds_read_b128 v[100:103], v40 offset:55296
    ds_read_b128 v[104:107], v40 offset:56320
    ds_read_b128 v[108:111], v40 offset:57344
    ds_read_b128 v[128:131], v40 offset:62464
    ds_read_b128 v[132:135], v40 offset:63488
    ds_read_b128 v[112:115], v40 offset:58368
    ds_read_b128 v[116:119], v40 offset:59392
    v_mul_u32_u24 v149, 3104, v41
    v_lshrrev_b32_e64 v42, 2, v0
    v_lshl_add_u32 v149, v42, 4, v149
    s_mul_i32 s11, s10, 3104
    v_add_u32 v151, s11, v40
    v_lshrrev_b32 v177, 3, v0
    v_add_u32 v177, v177, v0
    v_and_b32 v177, 3, v177
    v_lshlrev_b32_e64 v177, 4, v177
    v_lshl_add_u32 v177, v42, 6, v177
    v_lshl_add_u32 v42, v39, 6, v38
    v_mul_u32_u24_e64 v178, 48, v42
    s_mul_i32 s11, s10, 3
    s_and_b32 s12, s44, 1
    s_add_u32 s11, s11, s12
    s_lshl_b32 s11, s11, 1
    s_add_u32 s11, s11, 19456
    v_add_u32 v178, s11, v178
    v_lshrrev_b32 v176, 1, v38
    v_add_u32 v176, s10, v176
    v_and_b32 v176, 3, v176
    v_lshlrev_b32_e64 v176, 4, v176
    v_lshl_add_u32 v176, v42, 6, v176
    v_mov_b64 v[136:137], 0
    v_mov_b64 v[164:165], 0
    v_mov_b64 v[138:139], 0
    v_mov_b64 v[166:167], 0
    v_mov_b64 v[140:141], 0
    v_mov_b64 v[168:169], 0
    v_mov_b64 v[142:143], 0
    v_mov_b64 v[170:171], 0
    v_mov_b64 v[144:145], 0
    v_mov_b64 v[172:173], 0
    v_mov_b64 v[146:147], 0
    v_mov_b64 v[174:175], 0
    ds_read_u16_d16_hi v136, v178 offset:0
    ds_read_u16_d16_hi v164, v178 offset:12288
    ds_read_u16_d16_hi v137, v178 offset:768
    ds_read_u16_d16_hi v165, v178 offset:13056
    ds_read_u16_d16_hi v138, v178 offset:1536
    ds_read_u16_d16_hi v166, v178 offset:13824
    ds_read_u16_d16_hi v139, v178 offset:2304
    ds_read_u16_d16_hi v167, v178 offset:14592
    ds_read_u16_d16_hi v140, v178 offset:2
    ds_read_u16_d16_hi v168, v178 offset:12290
    ds_read_u16_d16_hi v141, v178 offset:770
    ds_read_u16_d16_hi v169, v178 offset:13058
    ds_read_u16_d16_hi v142, v178 offset:1538
    ds_read_u16_d16_hi v170, v178 offset:13826
    ds_read_u16_d16_hi v143, v178 offset:2306
    ds_read_u16_d16_hi v171, v178 offset:14594
    ds_read_u16_d16_hi v144, v178 offset:4
    ds_read_u16_d16_hi v172, v178 offset:12292
    ds_read_u16_d16_hi v145, v178 offset:772
    ds_read_u16_d16_hi v173, v178 offset:13060
    ds_read_u16_d16_hi v146, v178 offset:1540
    ds_read_u16_d16_hi v174, v178 offset:13828
    ds_read_u16_d16_hi v147, v178 offset:2308
    ds_read_u16_d16_hi v175, v178 offset:14596
    v_mov_b32 v217, v18
    v_mov_b32 v221, v18
    v_mov_b32 v225, v18
    v_mov_b32 v229, v18
    s_or_b32 s11, s17, s10
    s_cmp_eq_u32 s11, 0
    s_cselect_b32 s11, 0.5, 1.0
    s_waitcnt lgkmcnt(15)
    v_mul_f32 v136, s11, v136
    v_mul_f32 v164, s11, v164
    v_mul_f32 v137, s11, v137
    v_mul_f32 v165, s11, v165
    v_mul_f32 v138, s11, v138
    v_mul_f32 v166, s11, v166
    v_mul_f32 v139, s11, v139
    v_mul_f32 v167, s11, v167
    s_setprio 3
    s_waitcnt vmcnt(0)
    v_xor_b32 v41, v18, v183
    v_xor_b32 v187, v18, v187
    v_xor_b32 v191, v18, v191
    v_xor_b32 v195, v18, v195
    v_or3_b32 v41, v41, v187, v191
    v_or_b32 v41, v41, v195
    v_cmpx_ne_u32 vcc, 0, v41
    s_nop 0
    s_cbranch_execnz L_rty3
L_got2:
    s_mov_b64 exec, -1
    v_swap_b32 v181, v184
    v_swap_b32 v182, v188
    v_mov_b32 v183, v192
    ds_write_b128 v149, v[180:183] offset:0
    v_swap_b32 v186, v189
    v_mov_b32 v187, v193
    ds_write_b128 v149, v[184:187] offset:1024
    v_mov_b32_e64 v191, v194
    ds_write_b128 v149, v[188:191] offset:2048
    s_waitcnt lgkmcnt(0)
    s_barrier
    ds_read_b128 v[180:183], v151 offset:0
    ds_read_b128 v[184:187], v151 offset:1024
    ds_read_b128 v[188:191], v151 offset:2048
    s_waitcnt lgkmcnt(2)
    v_mfma_f32_16x16x32_bf16 v[22:25], v[180:183], v[88:91], 0
    v_mfma_f32_16x16x32_bf16 v[34:37], v[180:183], v[92:95], 0
    s_waitcnt lgkmcnt(1)
    v_mfma_f32_16x16x32_bf16 v[26:29], v[184:187], v[88:91], 0
    v_mfma_f32_16x16x32_bf16 v[196:199], v[184:187], v[92:95], 0
    s_waitcnt lgkmcnt(0)
    v_mfma_f32_16x16x32_bf16 v[30:33], v[188:191], v[88:91], 0
    v_mfma_f32_16x16x32_bf16 v[200:203], v[188:191], v[92:95], 0
    s_nop 0
    v_mul_f32 v205, v22, v120
    v_mul_f32 v209, v34, v120
    v_mul_f32 v206, v23, v121
    v_mul_f32 v210, v35, v121
    v_mul_f32 v207, v24, v122
    v_mul_f32 v211, v36, v122
    v_mul_f32 v208, v25, v123
    v_mul_f32 v212, v37, v123
    v_fmac_f32 v205, v34, v124
    v_fmac_f32 v206, v35, v125
    v_fmac_f32 v207, v36, v126
    v_fmac_f32 v208, v37, v127
    v_fma_f32 v209, -v22, v124, v209
    v_fma_f32 v210, -v23, v125, v210
    v_fma_f32 v211, -v24, v126, v211
    v_fma_f32 v212, -v25, v127, v212
    v_cvt_pk_bf16_f32 v180, v205, v209
    v_cvt_pk_bf16_f32 v181, v206, v210
    v_cvt_pk_bf16_f32 v182, v207, v211
    v_cvt_pk_bf16_f32 v183, v208, v212
    v_mul_f32 v205, v26, v120
    v_mul_f32 v209, v196, v120
    v_mfma_f32_16x16x32_bf16 v[22:25], v[96:99], v[180:183], 0
    v_mfma_f32_16x16x32_bf16 v[34:37], v[100:103], v[180:183], 0
    v_mul_f32 v206, v27, v121
    v_mul_f32 v210, v197, v121
    v_mul_f32 v207, v28, v122
    v_mul_f32 v211, v198, v122
    v_mul_f32 v208, v29, v123
    v_mul_f32 v212, v199, v123
    v_fmac_f32 v205, v196, v124
    v_fmac_f32 v206, v197, v125
    v_fmac_f32 v207, v198, v126
    v_fmac_f32 v208, v199, v127
    v_fma_f32 v209, -v26, v124, v209
    v_fma_f32 v210, -v27, v125, v210
    v_fma_f32 v211, -v28, v126, v211
    v_fma_f32 v212, -v29, v127, v212
    v_cvt_pk_bf16_f32 v184, v205, v209
    v_cvt_pk_bf16_f32 v185, v206, v210
    v_cvt_pk_bf16_f32 v186, v207, v211
    v_cvt_pk_bf16_f32 v187, v208, v212
    v_mul_f32 v205, v30, v120
    v_mul_f32 v209, v200, v120
    v_mfma_f32_16x16x32_bf16 v[26:29], v[96:99], v[184:187], 0
    v_mfma_f32_16x16x32_bf16 v[196:199], v[100:103], v[184:187], 0
    v_mul_f32 v206, v31, v121
    v_mul_f32 v210, v201, v121
    v_mul_f32 v207, v32, v122
    v_mul_f32 v211, v202, v122
    v_mul_f32 v208, v33, v123
    v_mul_f32 v212, v203, v123
    v_fmac_f32 v205, v200, v124
    v_fmac_f32 v206, v201, v125
    v_fmac_f32 v207, v202, v126
    v_fmac_f32 v208, v203, v127
    v_fma_f32 v209, -v30, v124, v209
    v_fma_f32 v210, -v31, v125, v210
    v_fma_f32 v211, -v32, v126, v211
    v_fma_f32 v212, -v33, v127, v212
    v_cvt_pk_bf16_f32 v188, v205, v209
    v_cvt_pk_bf16_f32 v189, v206, v210
    v_cvt_pk_bf16_f32 v190, v207, v211
    v_cvt_pk_bf16_f32 v191, v208, v212
    v_mul_f32 v205, v22, v136
    v_mul_f32 v209, v34, v136
    v_mfma_f32_16x16x32_bf16 v[30:33], v[96:99], v[188:191], 0
    v_mfma_f32_16x16x32_bf16 v[200:203], v[100:103], v[188:191], 0
    v_mul_f32 v206, v23, v137
    v_mul_f32 v210, v35, v137
    v_mul_f32 v207, v24, v138
    v_mul_f32 v211, v36, v138
    v_mul_f32 v208, v25, v139
    v_mul_f32 v212, v37, v139
    v_fmac_f32 v209, v22, v164
    v_fmac_f32 v210, v23, v165
    v_fmac_f32 v211, v24, v166
    v_fmac_f32 v212, v25, v167
    v_fma_f32 v205, -v34, v164, v205
    v_fma_f32 v206, -v35, v165, v206
    v_fma_f32 v207, -v36, v166, v207
    v_fma_f32 v208, -v37, v167, v208
    v_cvt_pk_bf16_f32 v180, v205, v209
    v_cvt_pk_bf16_f32 v181, v206, v210
    v_cvt_pk_bf16_f32 v182, v207, v211
    v_cvt_pk_bf16_f32 v183, v208, v212
    v_mul_f32 v205, v26, v140
    v_mul_f32 v209, v196, v140
    v_mfma_f32_16x16x32_bf16 v[22:25], v[180:183], v[104:107], 0
    v_mfma_f32_16x16x32_bf16 v[34:37], v[180:183], v[108:111], 0
    v_mul_f32 v206, v27, v141
    v_mul_f32 v210, v197, v141
    v_mul_f32 v207, v28, v142
    v_mul_f32 v211, v198, v142
    v_mul_f32 v208, v29, v143
    v_mul_f32 v212, v199, v143
    v_fmac_f32 v209, v26, v168
    v_fmac_f32 v210, v27, v169
    v_fmac_f32 v211, v28, v170
    v_fmac_f32 v212, v29, v171
    v_fma_f32 v205, -v196, v168, v205
    v_fma_f32 v206, -v197, v169, v206
    v_fma_f32 v207, -v198, v170, v207
    v_fma_f32 v208, -v199, v171, v208
    v_cvt_pk_bf16_f32 v184, v205, v209
    v_cvt_pk_bf16_f32 v185, v206, v210
    v_cvt_pk_bf16_f32 v186, v207, v211
    v_cvt_pk_bf16_f32 v187, v208, v212
    v_mul_f32 v205, v30, v144
    v_mul_f32 v209, v200, v144
    v_mfma_f32_16x16x32_bf16 v[26:29], v[184:187], v[104:107], 0
    v_mfma_f32_16x16x32_bf16 v[196:199], v[184:187], v[108:111], 0
    v_mul_f32 v206, v31, v145
    v_mul_f32 v210, v201, v145
    v_mul_f32 v207, v32, v146
    v_mul_f32 v211, v202, v146
    v_mul_f32 v208, v33, v147
    v_mul_f32 v212, v203, v147
    v_fmac_f32 v209, v30, v172
    v_fmac_f32 v210, v31, v173
    v_fmac_f32 v211, v32, v174
    v_fmac_f32 v212, v33, v175
    v_fma_f32 v205, -v200, v172, v205
    v_fma_f32 v206, -v201, v173, v206
    v_fma_f32 v207, -v202, v174, v207
    v_fma_f32 v208, -v203, v175, v208
    v_cvt_pk_bf16_f32 v188, v205, v209
    v_cvt_pk_bf16_f32 v189, v206, v210
    v_cvt_pk_bf16_f32 v190, v207, v211
    v_cvt_pk_bf16_f32 v191, v208, v212
    v_mul_f32 v205, v22, v128
    v_mul_f32 v209, v34, v128
    v_mfma_f32_16x16x32_bf16 v[30:33], v[188:191], v[104:107], 0
    v_mfma_f32_16x16x32_bf16 v[200:203], v[188:191], v[108:111], 0
    v_mul_f32 v206, v23, v129
    v_mul_f32 v210, v35, v129
    v_mul_f32 v207, v24, v130
    v_mul_f32 v211, v36, v130
    v_mul_f32 v208, v25, v131
    v_mul_f32 v212, v37, v131
    v_fmac_f32 v209, v22, v132
    v_fmac_f32 v210, v23, v133
    v_fmac_f32 v211, v24, v134
    v_fmac_f32 v212, v25, v135
    v_fma_f32 v205, -v34, v132, v205
    v_fma_f32 v206, -v35, v133, v206
    v_fma_f32 v207, -v36, v134, v207
    v_fma_f32 v208, -v37, v135, v208
    v_cvt_pk_bf16_f32 v180, v205, v209
    v_cvt_pk_bf16_f32 v181, v206, v210
    v_cvt_pk_bf16_f32 v182, v207, v211
    v_cvt_pk_bf16_f32 v183, v208, v212
    v_mul_f32 v205, v26, v128
    v_mul_f32 v209, v196, v128
    v_mfma_f32_16x16x32_bf16 v[22:25], v[112:115], v[180:183], 0
    v_mfma_f32_16x16x32_bf16 v[34:37], v[116:119], v[180:183], 0
    v_mul_f32 v206, v27, v129
    v_mul_f32 v210, v197, v129
    v_mul_f32 v207, v28, v130
    v_mul_f32 v211, v198, v130
    v_mul_f32 v208, v29, v131
    v_mul_f32 v212, v199, v131
    v_fmac_f32 v209, v26, v132
    v_fmac_f32 v210, v27, v133
    v_fmac_f32 v211, v28, v134
    v_fmac_f32 v212, v29, v135
    v_fma_f32 v205, -v196, v132, v205
    v_fma_f32 v206, -v197, v133, v206
    v_fma_f32 v207, -v198, v134, v207
    v_fma_f32 v208, -v199, v135, v208
    v_cvt_pk_bf16_f32 v184, v205, v209
    v_cvt_pk_bf16_f32 v185, v206, v210
    v_cvt_pk_bf16_f32 v186, v207, v211
    v_cvt_pk_bf16_f32 v187, v208, v212
    v_mul_f32 v205, v30, v128
    v_mul_f32 v209, v200, v128
    v_mfma_f32_16x16x32_bf16 v[26:29], v[112:115], v[184:187], 0
    v_mfma_f32_16x16x32_bf16 v[196:199], v[116:119], v[184:187], 0
    v_mul_f32 v206, v31, v129
    v_mul_f32 v210, v201, v129
    v_mul_f32 v207, v32, v130
    v_mul_f32 v211, v202, v130
    v_mul_f32 v208, v33, v131
    v_mul_f32 v212, v203, v131
    v_fmac_f32 v209, v30, v132
    v_fmac_f32 v210, v31, v133
    v_fmac_f32 v211, v32, v134
    v_fmac_f32 v212, v33, v135
    v_fma_f32 v205, -v200, v132, v205
    v_fma_f32 v206, -v201, v133, v206
    v_fma_f32 v207, -v202, v134, v207
    v_fma_f32 v208, -v203, v135, v208
    v_cvt_pk_bf16_f32 v188, v205, v209
    v_cvt_pk_bf16_f32 v189, v206, v210
    v_cvt_pk_bf16_f32 v190, v207, v211
    v_cvt_pk_bf16_f32 v191, v208, v212
    v_cvt_pk_bf16_f32 v214, v22, v34
    v_cvt_pk_bf16_f32 v218, v23, v35
    v_mfma_f32_16x16x32_bf16 v[30:33], v[112:115], v[188:191], 0
    v_mfma_f32_16x16x32_bf16 v[200:203], v[116:119], v[188:191], 0
    v_cvt_pk_bf16_f32 v222, v24, v36
    v_cvt_pk_bf16_f32 v226, v25, v37
    v_cvt_pk_bf16_f32 v215, v26, v196
    v_cvt_pk_bf16_f32 v219, v27, v197
    v_cvt_pk_bf16_f32 v223, v28, v198
    v_cvt_pk_bf16_f32 v227, v29, v199
    s_nop 1
    s_nop 0
    v_cvt_pk_bf16_f32 v216, v30, v200
    ds_write_b128 v176, v[214:217] offset:19456
    v_cvt_pk_bf16_f32 v220, v31, v201
    ds_write_b128 v176, v[218:221] offset:20480
    v_cvt_pk_bf16_f32 v224, v32, v202
    ds_write_b128 v176, v[222:225] offset:21504
    v_cvt_pk_bf16_f32 v228, v33, v203
    ds_write_b128 v176, v[226:229] offset:22528
    s_waitcnt lgkmcnt(0)
    s_barrier
    ds_read_b128 v[214:217], v177 offset:19456
    ds_read_b128 v[218:221], v177 offset:23552
    ds_read_b128 v[222:225], v177 offset:27648
    ds_read_b128 v[226:229], v177 offset:31744
    s_add_u32 s49, s16, 4096
    s_add_u32 s50, s16, 8192
    s_add_u32 s51, s16, 12288
    s_waitcnt lgkmcnt(3)
    buffer_store_dwordx4 v[214:217], v150, s[4:7], s16 offen sc1
    s_waitcnt lgkmcnt(2)
    buffer_store_dwordx4 v[218:221], v150, s[4:7], s49 offen sc1
    s_waitcnt lgkmcnt(1)
    buffer_store_dwordx4 v[222:225], v150, s[4:7], s50 offen sc1
    s_waitcnt lgkmcnt(0)
    buffer_store_dwordx4 v[226:229], v150, s[4:7], s51 offen sc1
    s_cmp_lg_u32 s10, 3
    s_cbranch_scc1 L_p3
    s_mov_b64 exec, 1
    s_add_u32 s11, s16, 16384
    v_mov_b32 v41, 0
    buffer_store_dword v18, v41, s[4:7], s11 offen sc1
    s_mov_b64 exec, -1
L_p3:
    s_setprio 3
    s_bitcmp1_b32 s10, 1
    s_cbranch_scc1 L_jc23
    s_bitcmp1_b32 s10, 0
    s_cbranch_scc1 L_jc1
    v_mul_f32 v45, 0x3d000000, v43
    v_mul_f32 v48, v45, v44
    v_add_f32 v49, v45, v48
    v_fmamk_f32 v50, v45, 0x40000000, v48
    v_fmamk_f32 v51, v45, 0x40400000, v48
    v_cos_f32 v56, v48
    v_sin_f32 v64, v48
    v_cos_f32 v57, v49
    v_sin_f32 v65, v49
    v_cos_f32 v58, v50
    v_sin_f32 v66, v50
    v_cos_f32 v59, v51
    v_sin_f32 v67, v51
    v_bfe_i32 v41, v38, 0, 1
    v_and_b32 v41, 0x80008000, v41
    v_cvt_pk_bf16_f32 v72, v56, -v64
    v_cvt_pk_bf16_f32 v73, v57, -v65
    v_cvt_pk_bf16_f32 v74, v58, -v66
    v_cvt_pk_bf16_f32 v75, v59, -v67
    v_xor_b32 v80, v41, v72
    v_xor_b32 v76, 0, v72
    v_xor_b32_e64 v81, v41, v73
    v_xor_b32 v77, 0x80008000, v73
    v_xor_b32 v82, v41, v74
    v_xor_b32 v78, 0, v74
    v_xor_b32_e64 v83, v41, v75
    v_xor_b32 v79, 0x80008000, v75
    v_xor_b32 v84, v41, v76
    v_xor_b32 v85, v41, v77
    v_xor_b32 v86, v41, v78
    v_xor_b32 v87, v41, v79
    ds_write_b128 v40, v[72:75] offset:48128
    ds_write_b128 v40, v[76:79] offset:49152
    ds_write_b128 v40, v[80:83] offset:50176
    ds_write_b128 v40, v[84:87] offset:51200
    s_branch L_jcd
L_jc1:
    v_and_b32 v46, 1, v39
    v_mul_f32 v45, 0x3d800000, v43
    v_cvt_f32_u32 v46, v46
    v_mul_f32 v46, 4.0, v46
    v_mul_f32_e64 v48, v46, v45
    v_bfe_i32 v41, v39, 1, 1
    v_and_b32 v41, 0x80008000, v41
    v_xor_b32 v42, 0x80008000, v41
    v_add_f32_e64 v49, v45, v48
    v_fmamk_f32 v50, v45, 0x40000000, v48
    v_fmamk_f32 v51, v45, 0x40400000, v48
    v_cos_f32 v56, v48
    v_sin_f32 v64, v48
    v_cos_f32 v57, v49
    v_sin_f32 v65, v49
    v_cos_f32 v58, v50
    v_sin_f32 v66, v50
    v_cos_f32 v59, v51
    v_sin_f32 v67, v51
    v_cvt_pk_bf16_f32 v72, v56, -v64
    v_cvt_pk_bf16_f32 v73, v57, -v65
    v_cvt_pk_bf16_f32 v74, v58, -v66
    v_cvt_pk_bf16_f32 v75, v59, -v67
    v_cvt_pk_bf16_f32 v76, v64, v56
    v_cvt_pk_bf16_f32 v77, v65, v57
    v_cvt_pk_bf16_f32 v78, v66, v58
    v_cvt_pk_bf16_f32 v79, v67, v59
    ds_write_b128 v40, v[72:75] offset:39936
    ds_write_b128 v40, v[76:79] offset:40960
    v_xor_b32 v80, v42, v76
    v_xor_b32 v84, v41, v72
    v_xor_b32 v81, v42, v77
    v_xor_b32 v85, v41, v73
    v_xor_b32 v82, v42, v78
    v_xor_b32 v86, v41, v74
    v_xor_b32 v83, v42, v79
    v_xor_b32 v87, v41, v75
    ds_write_b128 v40, v[80:83] offset:41984
    ds_write_b128 v40, v[84:87] offset:43008
    s_branch L_jcd
L_jc23:
    s_bitcmp1_b32 s10, 0
    s_cbranch_scc1 L_jc3
    v_mul_f32 v45, 0x3b000000, v43
    v_mul_f32 v48, v45, v44
    v_add_f32_e64 v49, v45, v48
    v_fmamk_f32 v50, v45, 0x40000000, v48
    v_fmamk_f32 v51, v45, 0x40400000, v48
    v_cos_f32 v56, v48
    v_sin_f32 v64, v48
    v_cos_f32 v57, v49
    v_sin_f32 v65, v49
    v_cos_f32 v58, v50
    v_sin_f32 v66, v50
    v_cos_f32 v59, v51
    v_sin_f32 v67, v51
    v_mul_f32 v56, 0x36000000, v56
    v_mul_f32 v64, 0x36000000, v64
    v_mul_f32 v57, 0x36000000, v57
    v_mul_f32 v65, 0x36000000, v65
    v_mul_f32 v58, 0x36000000, v58
    v_mul_f32 v66, 0x36000000, v66
    v_mul_f32 v59, 0x36000000, v59
    v_mul_f32 v67, 0x36000000, v67
    ds_write_b128 v40, v[56:59] offset:44032
    ds_write_b128 v40, v[64:67] offset:46080
    s_branch L_jcd
L_jc3:
    v_mul_f32 v45, 0x3b000000, v43
    v_add_f32 v46, 0x41800000, v44
    v_mul_f32 v48, v45, v46
    v_add_f32_e64 v49, v45, v48
    v_fmamk_f32 v50, v45, 0x40000000, v48
    v_fmamk_f32 v51, v45, 0x40400000, v48
    v_cos_f32 v56, v48
    v_sin_f32 v64, v48
    v_cos_f32 v57, v49
    v_sin_f32 v65, v49
    v_cos_f32 v58, v50
    v_sin_f32 v66, v50
    v_cos_f32 v59, v51
    v_sin_f32 v67, v51
    v_mul_f32 v56, 0x36000000, v56
    v_mul_f32 v64, 0x36000000, v64
    v_mul_f32 v57, 0x36000000, v57
    v_mul_f32 v65, 0x36000000, v65
    v_mul_f32 v58, 0x36000000, v58
    v_mul_f32 v66, 0x36000000, v66
    v_mul_f32 v59, 0x36000000, v59
    v_mul_f32 v67, 0x36000000, v67
    ds_write_b128 v40, v[56:59] offset:45056
    ds_write_b128 v40, v[64:67] offset:47104
L_jcd:
    v_dot2_f32_bf16 v176, v2, v19, 0
    v_dot2_f32_bf16 v177, v3, v19, 0
    v_dot2_f32_bf16 v178, v4, v19, 0
    v_dot2_f32_bf16 v179, v5, v19, 0
    v_dot2_f32_bf16 v180, v6, v19, 0
    v_dot2_f32_bf16 v181, v7, v19, 0
    v_dot2_f32_bf16 v182, v8, v19, 0
    v_dot2_f32_bf16 v183, v9, v19, 0
    s_lshl_b32 s11, s10, 5
    s_nop 0
    s_add_u32 s11, s11, 64512
    v_add_f32_dpp v184, v176, v176 row_ror:4 row_mask:0xf bank_mask:0x5
    v_add_f32_dpp v185, v178, v178 row_ror:4 row_mask:0xf bank_mask:0x5
    v_add_f32_dpp v186, v180, v180 row_ror:4 row_mask:0xf bank_mask:0x5
    v_add_f32_dpp v187, v182, v182 row_ror:4 row_mask:0xf bank_mask:0x5
    v_add_f32_dpp v184, v177, v177 row_ror:4 row_mask:0xf bank_mask:0xa
    v_add_f32_dpp v185, v179, v179 row_ror:4 row_mask:0xf bank_mask:0xa
    v_add_f32_dpp v186, v181, v181 row_ror:4 row_mask:0xf bank_mask:0xa
    v_add_f32_dpp v187, v183, v183 row_ror:4 row_mask:0xf bank_mask:0xa
    v_add_f32_dpp v176, v184, v184 row_ror:8 row_mask:0xf bank_mask:0x3
    v_add_f32_dpp v177, v186, v186 row_ror:8 row_mask:0xf bank_mask:0x3
    v_and_b32_e64 v178, 28, v0
    v_add_f32_dpp v176, v185, v185 row_ror:8 row_mask:0xf bank_mask:0xc
    v_add_f32_dpp v177, v187, v187 row_ror:8 row_mask:0xf bank_mask:0xc
    v_add_u32 v178, s11, v178
    s_nop 0
    v_permlane16_swap_b32 v176, v177
    v_add_f32 v176, v176, v177
    v_mov_b32_e64 v177, v176
    s_nop 1
    v_permlane32_swap_b32 v176, v177
    v_add_f32 v176, v176, v177
    s_nop 1
    v_add_f32_dpp v176, v176, v176 quad_perm:[1,0,3,2] row_mask:0xf bank_mask:0xf
    s_nop 1
    v_add_f32_dpp v176, v176, v176 quad_perm:[2,3,0,1] row_mask:0xf bank_mask:0xf
    ds_write_b32 v178, v176
    s_mul_i32 s16, s8, 12416
    s_add_u32 s16, s16, 9121792
    v_lshrrev_b32 v41, 2, v0
    v_mul_u32_u24 v21, 16512, v41
    v_and_b32_e64 v42, 3, v0
    v_lshl_add_u32 v21, v42, 4, v21
    v_add_u32 v133, 512, v0
    v_min_u32 v133, 703, v133
    v_lshrrev_b32_e64 v41, 2, v133
    v_mul_u32_u24 v132, 16512, v41
    v_and_b32_e64 v42, 3, v133
    v_lshl_add_u32 v132, v42, 4, v132
    v_lshlrev_b32 v133, 4, v133
    s_lshl_b32 s48, s8, 6
    s_add_u32 s48, s48, 6160384
    s_add_u32 s49, s48, 1056768
    s_mul_i32 s50, s8, 48
    s_add_u32 s50, s50, 9109504
    v_mul_u32_u24 v137, 48, v0
    v_mov_b32_e64 v46, v0
    v_mul_u32_u24 v134, 683, v46
    v_lshrrev_b32_e64 v134, 11, v134
    v_mul_u32_u24 v134, 12368, v134
    v_lshl_add_u32 v134, v46, 4, v134
    v_add_u32 v46, 256, v0
    v_mul_u32_u24 v135, 683, v46
    v_lshrrev_b32_e64 v135, 11, v135
    v_mul_u32_u24 v135, 12368, v135
    v_lshl_add_u32 v135, v46, 4, v135
    v_add_u32 v46, 512, v0
    v_mul_u32_u24 v136, 683, v46
    v_lshrrev_b32_e64 v136, 11, v136
    v_mul_u32_u24 v136, 12368, v136
    v_lshl_add_u32 v136, v46, 4, v136
    v_mov_b32_e64 v145, 0
    buffer_load_dword v144, v145, s[4:7], s16 offen sc1
    s_waitcnt lgkmcnt(0)
    s_barrier
    s_waitcnt vmcnt(0)
    s_cmp_lt_u32 s17, 22
    s_cbranch_scc1 L_t2go
    s_mul_i32 s11, s9, 22
    s_add_u32 s11, s11, s17
    s_sub_u32 s11, s11, 12
    s_mul_i32 s11, s11, 16512
    s_add_u32 s11, s11, 6176768
    s_mov_b64 exec, 1
    s_mov_b32 s13, 0
    s_setprio 0
    v_mov_b32 v42, 0
L_h2:
    buffer_load_dword v41, v42, s[4:7], s11 offen sc1
    s_add_u32 s13, s13, 1
    s_waitcnt vmcnt(0)
    v_cmp_ne_u32 vcc, s3, v41
    s_nop 0
    s_cbranch_vccz L_h2ok
    s_sleep 4
    s_cmp_lt_u32 s13, 20000
    s_cbranch_scc1 L_h2
L_h2ok:
    s_setprio 3
    s_mov_b64 exec, -1
    buffer_load_dword v144, v145, s[4:7], s16 offen sc1
    s_waitcnt vmcnt(0)
L_t2go:
    buffer_load_dwordx4 v[152:155], v21, s[4:7], s48 offen sc1
    buffer_load_dwordx4 v[156:159], v21, s[4:7], s49 offen sc1
    buffer_load_dwordx4 v[160:163], v132, s[4:7], s48 offen sc1
    v_cmp_ne_u32 vcc, s3, v144
    s_mov_b32 s45, 1
    s_cbranch_vccnz L_alate
    s_mov_b32 s45, 0
    buffer_load_dwordx4 v[164:167], v134, s[4:7], s50 offen sc1
    buffer_load_dwordx4 v[168:171], v135, s[4:7], s50 offen sc1
    buffer_load_dwordx4 v[172:175], v136, s[4:7], s50 offen sc1
    s_branch L_aiss
L_alate:
    s_nop 0
    buffer_load_dword v144, v145, s[4:7], s16 offen sc1
L_aiss:
    ds_read_b128 v[22:25], v40 offset:39936
    ds_read_b128 v[26:29], v40 offset:40960
    ds_read_b128 v[30:33], v40 offset:41984
    ds_read_b128 v[34:37], v40 offset:43008
    ds_read_b128 v[88:91], v40 offset:44032
    ds_read_b128 v[96:99], v40 offset:46080
    ds_read_b128 v[104:107], v40 offset:48128
    ds_read_b128 v[108:111], v40 offset:49152
    ds_read_b128 v[92:95], v40 offset:45056
    ds_read_b128 v[100:103], v40 offset:47104
    ds_read_b128 v[112:115], v40 offset:50176
    ds_read_b128 v[116:119], v40 offset:51200
    v_and_b32 v178, 7, v0
    v_lshlrev_b32 v178, 2, v178
    v_add_u32 v178, 64512, v178
    ds_read2_b32 v[180:181], v178 offset1:8
    ds_read2_b32 v[182:183], v178 offset0:16 offset1:24
    s_waitcnt lgkmcnt(1)
    v_add_f32 v180, v180, v181
    s_waitcnt lgkmcnt(0)
    v_add_f32 v182, v182, v183
    v_add_f32_e64 v176, v180, v182
    v_mul_f32 v176, 0xbfb8aa3b, v176
    v_exp_f32 v176, v176
    s_nop 0
    v_add_f32_e64 v176, 1.0, v176
    v_rcp_f32 v176, v176
    s_nop 0
    v_cvt_pk_bf16_f32 v176, v176, v176
    v_and_b32 v177, 0xffff0000, v176
    v_sub_f32_e64 v178, 1.0, v177
    v_readlane_b32 s56, v177, 0
    v_readlane_b32 s64, v178, 0
    v_readlane_b32 s57, v177, 1
    v_readlane_b32 s65, v178, 1
    v_readlane_b32 s58, v177, 2
    v_readlane_b32 s66, v178, 2
    v_readlane_b32 s59, v177, 3
    v_readlane_b32 s67, v178, 3
    v_readlane_b32 s60, v177, 4
    v_readlane_b32 s68, v178, 4
    v_readlane_b32 s61, v177, 5
    v_readlane_b32 s69, v178, 5
    v_readlane_b32 s62, v177, 6
    v_readlane_b32 s70, v178, 6
    v_readlane_b32 s63, v177, 7
    v_readlane_b32 s71, v178, 7
    s_lshr_b32 s36, s56, 16
    s_lshr_b32 s37, s57, 16
    s_lshr_b32 s38, s58, 16
    s_lshr_b32 s39, s59, 16
    s_lshr_b32 s40, s60, 16
    s_lshr_b32 s41, s61, 16
    s_lshr_b32 s42, s62, 16
    s_lshr_b32 s43, s63, 16
    s_cmp_lg_u32 s10, 0
    s_cbranch_scc1 L_nq
    v_bfe_i32 v147, v39, 1, 1
    v_not_b32 v146, v147
    v_and_b32 v30, v147, v22
    v_and_b32 v22, v146, v22
    v_and_b32 v31, v147, v23
    v_and_b32 v23, v146, v23
    v_and_b32 v32, v147, v24
    v_and_b32 v24, v146, v24
    v_and_b32 v33, v147, v25
    v_and_b32 v25, v146, v25
    v_and_b32 v34, v147, v26
    v_and_b32 v26, v146, v26
    v_and_b32 v35, v147, v27
    v_and_b32 v27, v146, v27
    v_and_b32 v36, v147, v28
    v_and_b32 v28, v146, v28
    v_and_b32 v37, v147, v29
    v_and_b32 v29, v146, v29
L_nq:
    s_cmp_lg_u32 s10, 0
    s_cselect_b32 s52, 0x3580, 0
    s_cselect_b32 s53, 0xb5800000, 0
    s_movk_i32 s54, 0x3580
    s_cmov_b32 s54, 0x35800000
    v_bfe_i32 v41, v38, 0, 1
    v_and_b32 v41, 0x80008000, v41
    v_add_u32 v42, -1, v39
    v_ashrrev_i32_e64 v42, 31, v42
    v_xor_b32 v120, 0x3580, v41
    v_xor_b32 v121, s52, v41
    v_xor_b32 v124, s53, v41
    v_xor_b32 v125, s54, v41
    v_and_b32 v120, v42, v120
    v_and_b32 v121, v42, v121
    v_and_b32 v124, v42, v124
    v_and_b32 v125, v42, v125
    v_mov_b64 v[122:123], 0
    v_mov_b64 v[126:127], 0
    v_mov_b64 v[130:131], 0
    v_and_b32_e64 v41, 1, v39
    v_lshl_add_u32 v41, v41, 7, v38
    v_lshrrev_b32_e64 v42, 1, v39
    v_mul_u32_u24 v42, 1408, v42
    s_mul_i32 s11, s10, 2816
    v_add_u32 v42, s11, v42
    v_mov_b32 v141, s11
    v_mul_u32_u24 v138, 171, v41
    v_lshrrev_b32 v138, 9, v138
    v_add_u32 v46, v41, v138
    v_lshl_add_u32 v138, v46, 2, v42
    v_add_u32_e64 v41, 16, v41
    v_mul_u32_u24 v139, 171, v41
    v_lshrrev_b32 v139, 9, v139
    v_add_u32 v46, v41, v139
    v_lshl_add_u32 v139, v46, 2, v42
    v_add_u32_e64 v41, 16, v41
    v_mul_u32_u24 v140, 171, v41
    v_lshrrev_b32 v140, 9, v140
    v_add_u32 v46, v41, v140
    v_lshl_add_u32 v140, v46, 2, v42
    v_bfe_u32 v41, v38, 1, 2
    v_xor_b32 v41, v41, v39
    v_lshlrev_b32 v41, 4, v41
    v_lshl_add_u32 v142, v38, 6, v41
    s_lshl_b32 s11, s10, 12
    v_add_u32 v142, s11, v142
    v_lshrrev_b32 v41, 3, v0
    v_xor_b32 v42, v41, v0
    v_and_b32 v42, 6, v42
    v_and_b32 v46, 1, v0
    v_or_b32 v42, v42, v46
    v_lshlrev_b32 v42, 3, v42
    v_lshl_add_u32 v143, v41, 6, v42
    s_setprio 3
    s_cmp_eq_u32 s45, 0
    s_cbranch_scc1 L_achk
    s_waitcnt vmcnt(0)
L_achk:
    s_waitcnt vmcnt(3)
    v_xor_b32 v41, v18, v155
    v_xor_b32 v159, v18, v159
    v_xor_b32 v163, v18, v163
    v_or3_b32 v41, v41, v159, v163
    v_cmpx_ne_u32 vcc, 0, v41
    s_nop 0
    s_cbranch_execnz L_rty6
L_got5:
    s_mov_b64 exec, -1
    ds_write_b128 v150, v[152:155] offset:0
    ds_write_b128 v150, v[156:159] offset:4096
    ds_write_b128 v133, v[160:163] offset:0
    v_cmp_ne_u32 vcc, s3, v144
    s_cmp_eq_u32 s45, 0
    s_cbranch_scc1 L_a2
    s_cbranch_vccnz L_a2
    s_mov_b32 s45, 0
    buffer_load_dwordx4 v[164:167], v134, s[4:7], s50 offen sc1
    buffer_load_dwordx4 v[168:171], v135, s[4:7], s50 offen sc1
    buffer_load_dwordx4 v[172:175], v136, s[4:7], s50 offen sc1
L_a2:
    s_waitcnt lgkmcnt(0)
    s_barrier
    s_nop 0
    ds_read_b32 v152, v138 offset:0
    ds_read_b32 v153, v140 offset:0
    ds_read_b32 v154, v139 offset:256
    ds_read_b32 v155, v138 offset:512
    ds_read_b32 v156, v139 offset:0
    ds_read_b32 v157, v138 offset:256
    ds_read_b32 v158, v140 offset:256
    ds_read_b32 v159, v139 offset:512
    ds_read_b32 v128, v141 offset:1364
    ds_read_b32 v129, v141 offset:2772
    s_waitcnt lgkmcnt(6)
    v_mfma_f32_16x16x32_bf16 v[2:5], v[152:155], v[22:25], 0
    v_mfma_f32_16x16x32_bf16 v[56:59], v[152:155], v[26:29], 0
    v_mfma_f32_16x16x32_bf16 v[48:51], v[152:155], v[30:33], 0
    v_mfma_f32_16x16x32_bf16 v[64:67], v[152:155], v[34:37], 0
    s_waitcnt lgkmcnt(2)
    v_mfma_f32_16x16x32_bf16 v[6:9], v[156:159], v[22:25], 0
    v_mfma_f32_16x16x32_bf16 v[60:63], v[156:159], v[26:29], 0
    v_mfma_f32_16x16x32_bf16 v[52:55], v[156:159], v[30:33], 0
    v_mfma_f32_16x16x32_bf16 v[68:71], v[156:159], v[34:37], 0
    v_mul_f32 v205, v2, v88
    v_mul_f32 v209, v56, v88
    v_mul_f32 v206, v3, v89
    v_mul_f32 v210, v57, v89
    v_mul_f32 v207, v4, v90
    v_mul_f32 v211, v58, v90
    v_mul_f32_e64 v208, v5, v91
    v_mul_f32 v212, v59, v91
    s_waitcnt lgkmcnt(0)
    v_mfma_f32_16x16x32_bf16 v[80:83], v[120:123], v[128:131], 0
    v_mfma_f32_16x16x32_bf16 v[84:87], v[120:123], v[128:131], 0
    v_fmac_f32 v209, v2, v96
    v_fmac_f32 v210, v3, v97
    v_fmac_f32 v211, v4, v98
    v_fmac_f32 v212, v5, v99
    v_fma_f32 v205, -v56, v96, v205
    v_fma_f32 v206, -v57, v97, v206
    v_fma_f32 v207, -v58, v98, v207
    v_fma_f32 v208, -v59, v99, v208
    v_cvt_pk_bf16_f32 v72, v205, v209
    v_cvt_pk_bf16_f32 v73, v206, v210
    v_cvt_pk_bf16_f32 v74, v207, v211
    v_cvt_pk_bf16_f32 v75, v208, v212
    v_mul_f32 v205, v6, v92
    v_mul_f32 v209, v60, v92
    v_mfma_f32_16x16x32_bf16 v[80:83], v[72:75], v[104:107], v[80:83]
    v_mfma_f32_16x16x32_bf16 v[84:87], v[72:75], v[108:111], v[84:87]
    v_mul_f32 v206, v7, v93
    v_mul_f32 v210, v61, v93
    v_mul_f32 v207, v8, v94
    v_mul_f32 v211, v62, v94
    v_mul_f32 v208, v9, v95
    v_mul_f32 v212, v63, v95
    v_fmac_f32 v209, v6, v100
    v_fmac_f32 v210, v7, v101
    v_fmac_f32 v211, v8, v102
    v_fmac_f32 v212, v9, v103
    v_fma_f32 v205, -v60, v100, v205
    v_fma_f32 v206, -v61, v101, v206
    v_fma_f32 v207, -v62, v102, v207
    v_fma_f32 v208, -v63, v103, v208
    v_cvt_pk_bf16_f32 v76, v205, v209
    v_cvt_pk_bf16_f32 v77, v206, v210
    v_cvt_pk_bf16_f32 v78, v207, v211
    v_cvt_pk_bf16_f32 v79, v208, v212
    v_mul_f32 v205, v48, v88
    v_mul_f32 v209, v64, v88
    v_mfma_f32_16x16x32_bf16 v[80:83], v[76:79], v[112:115], v[80:83]
    v_mfma_f32_16x16x32_bf16 v[84:87], v[76:79], v[116:119], v[84:87]
    v_mul_f32 v206, v49, v89
    v_mul_f32 v210, v65, v89
    v_mul_f32 v207, v50, v90
    v_mul_f32 v211, v66, v90
    v_mul_f32 v208, v51, v91
    v_mul_f32 v212, v67, v91
    v_mfma_f32_16x16x32_bf16 v[176:179], v[124:127], v[128:131], 0
    v_mfma_f32_16x16x32_bf16 v[180:183], v[124:127], v[128:131], 0
    v_fmac_f32 v209, v48, v96
    v_fmac_f32 v210, v49, v97
    v_fmac_f32 v211, v50, v98
    v_fmac_f32 v212, v51, v99
    v_fma_f32 v205, -v64, v96, v205
    v_fma_f32 v206, -v65, v97, v206
    v_fma_f32 v207, -v66, v98, v207
    v_fma_f32 v208, -v67, v99, v208
    v_cvt_pk_bf16_f32 v72, v205, v209
    v_cvt_pk_bf16_f32 v73, v206, v210
    v_cvt_pk_bf16_f32 v74, v207, v211
    v_cvt_pk_bf16_f32 v75, v208, v212
    v_mul_f32 v205, v52, v92
    v_mul_f32 v209, v68, v92
    v_mfma_f32_16x16x32_bf16 v[176:179], v[72:75], v[104:107], v[176:179]
    v_mfma_f32_16x16x32_bf16 v[180:183], v[72:75], v[108:111], v[180:183]
    v_mul_f32 v206, v53, v93
    v_mul_f32 v210, v69, v93
    v_mul_f32 v207, v54, v94
    v_mul_f32 v211, v70, v94
    v_mul_f32 v208, v55, v95
    v_mul_f32 v212, v71, v95
    ds_write_b128 v142, v[80:83] offset:19456
    ds_write_b128 v142, v[84:87] offset:20480
    v_fmac_f32 v209, v52, v100
    v_fmac_f32 v210, v53, v101
    v_fmac_f32 v211, v54, v102
    v_fmac_f32 v212, v55, v103
    v_fma_f32 v205, -v68, v100, v205
    v_fma_f32 v206, -v69, v101, v206
    v_fma_f32 v207, -v70, v102, v207
    v_fma_f32 v208, -v71, v103, v208
    v_cvt_pk_bf16_f32 v76, v205, v209
    v_cvt_pk_bf16_f32 v77, v206, v210
    v_cvt_pk_bf16_f32 v78, v207, v211
    v_cvt_pk_bf16_f32 v79, v208, v212
    s_nop 1
    v_mfma_f32_16x16x32_bf16 v[176:179], v[76:79], v[112:115], v[176:179]
    v_mfma_f32_16x16x32_bf16 v[180:183], v[76:79], v[116:119], v[180:183]
    s_cmp_eq_u32 s45, 0
    s_cbranch_scc1 L_ago
    s_mov_b64 exec, 1
    s_mov_b32 s13, 0
    s_setprio 0
    v_mov_b32_e64 v42, 0
L_h3:
    buffer_load_dword v41, v42, s[4:7], s16 offen sc1
    s_add_u32 s13, s13, 1
    s_waitcnt vmcnt(0)
    v_cmp_ne_u32 vcc, s3, v41
    s_nop 0
    s_cbranch_vccz L_h3ok
    s_sleep 4
    s_cmp_lt_u32 s13, 20000
    s_cbranch_scc1 L_h3
L_h3ok:
    s_setprio 3
    s_mov_b64 exec, -1
    buffer_load_dwordx4 v[164:167], v134, s[4:7], s50 offen sc1
    buffer_load_dwordx4 v[168:171], v135, s[4:7], s50 offen sc1
    buffer_load_dwordx4 v[172:175], v136, s[4:7], s50 offen sc1
L_ago:
    s_waitcnt vmcnt(0)
    v_xor_b32 v41, v18, v167
    v_xor_b32 v171, v18, v171
    v_xor_b32_e64 v175, v18, v175
    v_or3_b32 v41, v41, v171, v175
    v_cmpx_ne_u32 vcc, 0, v41
    s_nop 0
    s_cbranch_execnz L_rty9
L_got8:
    s_mov_b64 exec, -1
    ds_write_b128 v150, v[164:167] offset:35840
    ds_write_b128 v150, v[168:171] offset:39936
    ds_write_b128 v150, v[172:175] offset:44032
    ds_write_b128 v142, v[176:179] offset:21504
    ds_write_b128 v142, v[180:183] offset:22528
    s_waitcnt lgkmcnt(0)
    s_barrier
    ds_read_b64 v[44:45], v143 offset:19456
    ds_read_b64 v[184:185], v143 offset:21504
    ds_read_b64 v[214:215], v143 offset:27648
    ds_read_b64 v[216:217], v143 offset:29696
    ds_read_b96 v[164:166], v137 offset:35840
    ds_read_b96 v[168:170], v137 offset:35856
    ds_read_b96 v[172:174], v137 offset:35872
    ds_read_b64 v[186:187], v143 offset:23552
    ds_read_b64 v[218:219], v143 offset:31744
    ds_read_b64 v[202:203], v143 offset:25600
    ds_read_b64 v[220:221], v143 offset:33792
    s_waitcnt lgkmcnt(9)
    v_pk_add_f32 v[230:231], v[44:45], v[184:185]
    v_pk_add_f32 v[232:233], v[44:45], v[184:185] neg_lo:[0,1] neg_hi:[0,1]
    s_waitcnt lgkmcnt(8)
    v_pk_add_f32 v[222:223], v[230:231], v[214:215]
    v_pk_add_f32 v[226:227], v[230:231], v[214:215] neg_lo:[0,1] neg_hi:[0,1]
    s_waitcnt lgkmcnt(7)
    v_pk_add_f32 v[224:225], v[232:233], v[216:217]
    v_pk_add_f32 v[228:229], v[232:233], v[216:217] neg_lo:[0,1] neg_hi:[0,1]
    s_waitcnt lgkmcnt(6)
    v_dot2_f32_bf16 v148, v164, s36, 0
    v_dot2_f32_bf16 v149, v164, s56, 0
    s_waitcnt lgkmcnt(5)
    v_dot2_f32_bf16 v194, v169, s40, 0
    v_dot2_f32_bf16 v195, v169, s60, 0
    v_dot2_f32_bf16 v190, v166, s38, 0
    v_dot2_f32_bf16 v191, v166, s58, 0
    s_waitcnt lgkmcnt(4)
    v_dot2_f32_bf16 v198, v172, s42, 0
    v_dot2_f32_bf16 v199, v172, s62, 0
    s_waitcnt lgkmcnt(2)
    s_nop 0
    v_pk_add_f32 v[234:235], v[186:187], v[218:219]
    v_pk_add_f32 v[230:231], v[186:187], v[218:219] neg_lo:[0,1] neg_hi:[0,1]
    v_pk_add_f32 v[44:45], v[222:223], v[234:235]
    v_pk_add_f32 v[214:215], v[222:223], v[234:235] neg_lo:[0,1] neg_hi:[0,1]
    v_pk_fma_f32 v[44:45], v[44:45], s[64:65], v[148:149] op_sel_hi:[1,0,1]
    v_pk_fma_f32 v[214:215], v[214:215], s[68:69], v[194:195] op_sel_hi:[1,0,1]
    s_waitcnt lgkmcnt(0)
    s_nop 0
    v_pk_add_f32 v[238:239], v[202:203], v[220:221] neg_lo:[0,1] neg_hi:[0,1]
    v_pk_add_f32 v[232:233], v[202:203], v[220:221]
    v_cvt_pk_bf16_f32 v242, v44, v45
    global_store_dword v10, v242, s[30:31]
    v_cvt_pk_bf16_f32 v246, v214, v215
    global_store_dword v14, v246, s[30:31]
    v_pk_add_f32 v[186:187], v[226:227], v[238:239]
    v_pk_add_f32 v[218:219], v[226:227], v[238:239] neg_lo:[0,1] neg_hi:[0,1]
    v_pk_add_f32 v[236:237], v[232:233], v[230:231]
    v_pk_add_f32 v[240:241], v[232:233], v[230:231] neg_lo:[0,1] neg_hi:[0,1]
    v_pk_fma_f32 v[186:187], v[186:187], s[66:67], v[190:191] op_sel_hi:[1,0,1]
    v_pk_fma_f32 v[218:219], v[218:219], s[70:71], v[198:199] op_sel_hi:[1,0,1]
    v_dot2_f32_bf16 v188, v165, s37, 0
    v_dot2_f32_bf16 v189, v165, s57, 0
    v_dot2_f32_bf16 v196, v170, s41, 0
    v_dot2_f32_bf16 v197, v170, s61, 0
    v_dot2_f32_bf16 v192, v168, s39, 0
    v_dot2_f32_bf16 v193, v168, s59, 0
    v_dot2_f32_bf16 v200, v173, s43, 0
    v_dot2_f32_bf16 v201, v173, s63, 0
    v_pk_fma_f32 v[184:185], v[236:237], s[46:47], v[224:225] op_sel_hi:[1,0,1]
    v_pk_fma_f32 v[216:217], v[236:237], s[46:47], v[224:225] op_sel_hi:[1,0,1] neg_lo:[1,0,0] neg_hi:[1,0,0]
    v_cvt_pk_bf16_f32 v244, v186, v187
    global_store_dword v12, v244, s[30:31]
    v_cvt_pk_bf16_f32 v248, v218, v219
    global_store_dword v16, v248, s[30:31]
    v_pk_fma_f32 v[202:203], v[240:241], s[46:47], v[228:229] op_sel_hi:[1,0,1]
    v_pk_fma_f32 v[220:221], v[240:241], s[46:47], v[228:229] op_sel_hi:[1,0,1] neg_lo:[1,0,0] neg_hi:[1,0,0]
    v_pk_fma_f32 v[184:185], v[184:185], s[64:65], v[188:189] op_sel:[0,1,0]
    v_pk_fma_f32 v[216:217], v[216:217], s[68:69], v[196:197] op_sel:[0,1,0]
    v_pk_fma_f32 v[202:203], v[202:203], s[66:67], v[192:193] op_sel:[0,1,0]
    v_pk_fma_f32 v[220:221], v[220:221], s[70:71], v[200:201] op_sel:[0,1,0]
    v_cvt_pk_bf16_f32 v243, v184, v185
    global_store_dword v11, v243, s[30:31]
    v_cvt_pk_bf16_f32 v247, v216, v217
    global_store_dword v15, v247, s[30:31]
    v_cvt_pk_bf16_f32 v245, v202, v203
    global_store_dword v13, v245, s[30:31]
    v_cvt_pk_bf16_f32 v249, v220, v221
    global_store_dword v17, v249, s[30:31]
    s_or_b32 s11, s2, s10
    s_cmp_lg_u32 s11, 0
    s_cbranch_scc1 L_fdone
    v_mov_b32 v41, 0
    s_mov_b64 exec, 1
    buffer_store_dword v18, v41, s[4:7], 0 offen
    s_mov_b64 exec, -1
L_fdone:
    s_endpgm
L_rty3:
    s_mov_b32 s13, 0
    s_setprio 0
L_chk1:
    s_sleep 2
    buffer_load_dwordx4 v[180:183], v148, s[4:7], s48 offen sc1
    buffer_load_dwordx4 v[184:187], v148, s[4:7], s49 offen sc1
    buffer_load_dwordx4 v[188:191], v148, s[4:7], s50 offen sc1
    buffer_load_dwordx4 v[192:195], v148, s[4:7], s51 offen sc1
    s_add_u32 s13, s13, 1
    s_waitcnt vmcnt(0)
    v_xor_b32 v41, v18, v183
    v_xor_b32 v187, v18, v187
    v_xor_b32 v191, v18, v191
    v_xor_b32 v195, v18, v195
    v_or3_b32 v41, v41, v187, v191
    v_or_b32 v41, v41, v195
    v_cmpx_ne_u32 vcc, 0, v41
    s_nop 0
    s_cbranch_execz L_chk1x
    s_cmp_lt_u32 s13, 20000
    s_cbranch_scc1 L_chk1
L_chk1x:
    s_setprio 3
    s_branch L_got2
L_rty6:
    s_mov_b32 s13, 0
    s_setprio 0
L_chk4:
    s_sleep 2
    buffer_load_dwordx4 v[152:155], v21, s[4:7], s48 offen sc1
    buffer_load_dwordx4 v[156:159], v21, s[4:7], s49 offen sc1
    buffer_load_dwordx4 v[160:163], v132, s[4:7], s48 offen sc1
    s_add_u32 s13, s13, 1
    s_waitcnt vmcnt(0)
    v_xor_b32 v41, v18, v155
    v_xor_b32 v159, v18, v159
    v_xor_b32_e64 v163, v18, v163
    v_or3_b32 v41, v41, v159, v163
    v_cmpx_ne_u32 vcc, 0, v41
    s_nop 0
    s_cbranch_execz L_chk4x
    s_cmp_lt_u32 s13, 20000
    s_cbranch_scc1 L_chk4
L_chk4x:
    s_setprio 3
    s_branch L_got5
L_rty9:
    s_mov_b32 s13, 0
    s_setprio 0
L_chk7:
    s_sleep 4
    buffer_load_dwordx4 v[164:167], v134, s[4:7], s50 offen sc1
    buffer_load_dwordx4 v[168:171], v135, s[4:7], s50 offen sc1
    buffer_load_dwordx4 v[172:175], v136, s[4:7], s50 offen sc1
    s_add_u32 s13, s13, 1
    s_waitcnt vmcnt(0)
    v_xor_b32 v41, v18, v167
    v_xor_b32 v171, v18, v171
    v_xor_b32 v175, v18, v175
    v_or3_b32 v41, v41, v171, v175
    v_cmpx_ne_u32 vcc, 0, v41
    s_nop 0
    s_cbranch_execz L_chk7x
    s_cmp_lt_u32 s13, 20000
    s_cbranch_scc1 L_chk7
L_chk7x:
    s_setprio 3
    s_branch L_got8
L_conv:
    s_load_dwordx16 s[20:35], s[0:1], 0
    s_load_dwordx2 s[4:5], s[0:1], 120
    s_load_dwordx2 s[48:49], s[0:1], 64
    s_getpc_b64 s[14:15]
L_pcref:
    s_setprio 2
    s_mov_b32 s19, s12
    v_lshrrev_b32 v1, 3, v0
    v_and_b32 v2, 7, v0
    v_lshlrev_b32 v40, 10, v1
    v_lshl_add_u32 v40, v2, 4, v40
    s_lshl_b32 s11, s19, 16
    s_lshl_b32 s12, s9, 7
    s_add_u32 s11, s11, s12
    v_add_u32 v40, s11, v40
    v_add_u32 v3, 32768, v40
    s_lshl_b32 s11, s8, 9
    v_lshl_add_u32 v38, v0, 1, s11
    s_lshr_b32 s17, s10, 1
    s_lshl_b32 s11, s8, 1
    s_add_u32 s11, s11, s17
    s_lshl_b32 s11, s11, 1
    v_mov_b32 v39, s11
    v_mov_b32 v5, 0
    s_waitcnt lgkmcnt(0)
    global_load_dwordx4 v[30:33], v40, s[20:21]
    global_load_dwordx4 v[34:37], v3, s[20:21]
    global_load_dword v5, v5, s[4:5]
    global_load_ushort v28, v39, s[34:35]
    global_load_ushort v22, v38, s[22:23]
    global_load_ushort v23, v38, s[24:25]
    global_load_ushort v24, v38, s[26:27]
    global_load_ushort v25, v38, s[28:29]
    global_load_ushort v26, v38, s[30:31]
    global_load_ushort v27, v38, s[32:33]
    s_lshl_b32 s11, s8, 2
    s_load_dword s54, s[48:49], s11
    s_mov_b32 s6, 12582912
    s_mov_b32 s7, 0x20000
    s_and_b32 s18, s10, 1
    v_mul_u32_u24 v3, 1424, v2
    v_add_u32 v3, 66112, v3
    v_xor_b32 v1, 7, v1
    v_and_b32 v2, 1, v1
    v_lshl_add_u32 v3, v2, 1, v3
    v_lshrrev_b32_e64 v1, 1, v1
    v_mul_u32_u24 v2, 171, v1
    v_lshrrev_b32 v2, 9, v2
    v_add_u32 v2, v1, v2
    v_lshl_add_u32 v44, v2, 2, v3
    v_add_u32_e64 v1, 16, v1
    v_mul_u32_u24 v2, 171, v1
    v_lshrrev_b32 v2, 9, v2
    v_add_u32 v2, v1, v2
    v_lshl_add_u32 v45, v2, 2, v3
    v_lshlrev_b32_e64 v21, 4, v0
    v_add_u32 v46, 66112, v21
    v_sub_u32 v47, 199, v0
    v_and_b32 v47, 0x40000000, v47
    v_add_u32 v47, v47, v21
    s_mul_i32 s11, s8, 11520
    s_add_u32 s50, s11, 4096
    s_add_u32 s51, s50, 4096
    s_add_u32 s52, s50, 8192
    s_mul_i32 s11, s17, 28832
    s_add_u32 s11, s11, 8448
    v_and_b32 v1, 127, v0
    v_lshl_add_u32 v48, v1, 2, s11
    s_mov_b32 s12, 0x9E3779B1
    s_waitcnt vmcnt(9)
    s_nop 0
    ds_write_b16 v44, v30 offset:0
    ds_write_b16_d16_hi v44, v30 offset:176
    ds_write_b16 v44, v31 offset:352
    ds_write_b16_d16_hi v44, v31 offset:528
    ds_write_b16 v44, v32 offset:704
    ds_write_b16_d16_hi v44, v32 offset:880
    ds_write_b16 v44, v33 offset:1056
    ds_write_b16_d16_hi v44, v33 offset:1232
    s_waitcnt vmcnt(8)
    s_nop 0
    ds_write_b16 v45, v34 offset:0
    ds_write_b16_d16_hi v45, v34 offset:176
    ds_write_b16 v45, v35 offset:352
    ds_write_b16_d16_hi v45, v35 offset:528
    ds_write_b16 v45, v36 offset:704
    ds_write_b16_d16_hi v45, v36 offset:880
    ds_write_b16 v45, v37 offset:1056
    ds_write_b16_d16_hi v45, v37 offset:1232
    s_waitcnt vmcnt(7)
    v_mul_lo_u32 v5, v5, s12
    v_add_u32 v5, 0x7F4A7C15, v5
    v_mov_b32 v53, v5
    v_mov_b32_e64 v57, v5
    v_mov_b32 v61, v5
    v_readfirstlane_b32 s3, v5
    s_waitcnt lgkmcnt(0)
    s_barrier
    ds_read_b96 v[50:52], v46 offset:0
    ds_read_b96 v[54:56], v46 offset:4096
    ds_read_b96 v[58:60], v46 offset:8192
    s_waitcnt vmcnt(6)
    v_lshlrev_b32 v49, 16, v28
    v_mul_f32 v64, 0x3fb8aa3b, v49
    s_mov_b32 s11, 0x3fb8aa3b
    v_fma_f32 v65, v49, s11, -v64
    v_exp_f32_e64 v64, v64
    v_fmamk_f32 v65, v49, 0x32a57060, v65
    v_mul_f32 v65, 0x3f317218, v65
    v_fma_f32 v49, v64, v65, v64
    s_waitcnt lgkmcnt(2)
    buffer_store_dwordx4 v[50:53], v21, s[4:7], s50 offen sc1
    s_waitcnt lgkmcnt(1)
    buffer_store_dwordx4 v[54:57], v21, s[4:7], s51 offen sc1
    s_waitcnt lgkmcnt(0)
    buffer_store_dwordx4 v[58:61], v47, s[4:7], s52 offen sc1
    v_cvt_pk_bf16_f32 v49, v49, v49
    s_waitcnt vmcnt(8)
    v_lshlrev_b32_e64 v62, 16, v22
    v_and_b32 v49, 0xffff0000, v49
    s_waitcnt vmcnt(7)
    v_lshlrev_b32 v63, 16, v23
    v_mul_f32 v62, v49, v62
    v_mul_f32 v63, v49, v63
    v_mul_f32 v62, 0x3fb8aa3b, v62
    v_mul_f32_e64 v63, 0.15915494, v63
    v_mul_f32 v64, 0x41000000, v62
    v_mul_f32 v68, 0x41000000, v63
    v_mul_f32 v66, 0x43800000, v62
    v_mul_f32 v70, 0x43800000, v63
    v_exp_f32 v64, v64
    v_fract_f32 v68, v68
    v_exp_f32 v65, v62
    v_fract_f32 v69, v63
    v_exp_f32 v66, v66
    v_fract_f32 v70, v70
    v_cos_f32 v74, v68
    v_sin_f32 v75, v68
    v_cos_f32 v72, v69
    v_sin_f32 v73, v69
    v_cos_f32 v76, v70
    v_sin_f32 v77, v70
    s_waitcnt vmcnt(6)
    v_lshlrev_b32 v78, 16, v24
    s_waitcnt vmcnt(5)
    v_lshlrev_b32 v79, 16, v25
    s_waitcnt vmcnt(4)
    v_lshlrev_b32 v80, 16, v26
    s_waitcnt vmcnt(3)
    v_lshlrev_b32 v81, 16, v27
    v_mul_f32 v78, v49, v78
    v_mul_f32 v79, v49, v79
    v_mul_f32 v74, v64, v74
    v_mul_f32 v75, v64, v75
    v_mul_f32 v72, v65, v72
    v_mul_f32 v73, v65, v73
    v_mul_f32 v76, v66, v76
    v_mul_f32 v77, v66, v77
    v_mov_b32 v82, 0x3f80
    ds_write_b32 v48, v82 offset:0
    v_pk_mul_f32 v[104:105], v[74:75], v[74:75] op_sel_hi:[0,1]
    v_pk_mul_f32 v[114:115], v[80:81], v[78:79] op_sel_hi:[0,1]
    v_pk_fma_f32 v[104:105], v[74:75], v[74:75], v[104:105] op_sel:[1,1,0] op_sel_hi:[1,0,1] neg_lo:[1,0,0]
    v_pk_fma_f32 v[114:115], v[80:81], v[78:79], v[114:115] op_sel:[1,1,0] op_sel_hi:[1,0,1] neg_lo:[1,0,0]
    v_cvt_pk_bf16_f32 v94, v74, v75
    ds_write_b32 v48, v94 offset:544
    v_pk_mul_f32 v[108:109], v[104:105], v[74:75] op_sel_hi:[0,1]
    v_pk_mul_f32 v[112:113], v[104:105], v[104:105] op_sel_hi:[0,1]
    v_pk_fma_f32 v[108:109], v[104:105], v[74:75], v[108:109] op_sel:[1,1,0] op_sel_hi:[1,0,1] neg_lo:[1,0,0]
    v_pk_fma_f32 v[112:113], v[104:105], v[104:105], v[112:113] op_sel:[1,1,0] op_sel_hi:[1,0,1] neg_lo:[1,0,0]
    v_cvt_pk_bf16_f32 v95, v104, v105
    ds_write_b32 v48, v95 offset:1088
    v_cvt_pk_bf16_f32 v94, v114, -v115
    ds_write_b32 v48, v94 offset:17408
    v_cvt_pk_bf16_f32 v83, v112, v113
    v_pk_mul_f32 v[102:103], v[74:75], v[112:113] op_sel_hi:[0,1]
    v_pk_mul_f32 v[106:107], v[104:105], v[112:113] op_sel_hi:[0,1]
    v_cvt_pk_bf16_f32 v88, v108, v109
    v_pk_mul_f32 v[116:117], v[114:115], v[72:73] op_sel_hi:[0,1]
    v_pk_fma_f32 v[116:117], v[114:115], v[72:73], v[116:117] op_sel:[1,1,0] op_sel_hi:[1,0,1] neg_lo:[1,0,0]
    v_pk_mul_f32 v[130:131], v[114:115], v[76:77] op_sel_hi:[0,1]
    ds_write_b32 v48, v83 offset:2176
    v_pk_fma_f32 v[102:103], v[74:75], v[112:113], v[102:103] op_sel:[1,1,0] op_sel_hi:[1,0,1] neg_lo:[1,0,0]
    v_pk_fma_f32 v[106:107], v[104:105], v[112:113], v[106:107] op_sel:[1,1,0] op_sel_hi:[1,0,1] neg_lo:[1,0,0]
    ds_write_b32 v48, v88 offset:1632
    v_cvt_pk_bf16_f32 v90, v116, -v117
    ds_write_b32 v48, v90 offset:17952
    v_pk_fma_f32 v[130:131], v[114:115], v[76:77], v[130:131] op_sel:[1,1,0] op_sel_hi:[1,0,1] neg_lo:[1,0,0]
    v_pk_mul_f32 v[98:99], v[112:113], v[112:113] op_sel_hi:[0,1]
    v_cvt_pk_bf16_f32 v84, v102, v103
    v_cvt_pk_bf16_f32 v87, v106, v107
    v_pk_mul_f32 v[110:111], v[108:109], v[112:113] op_sel_hi:[0,1]
    v_pk_mul_f32 v[118:119], v[116:117], v[72:73] op_sel_hi:[0,1]
    v_pk_fma_f32 v[118:119], v[116:117], v[72:73], v[118:119] op_sel:[1,1,0] op_sel_hi:[1,0,1] neg_lo:[1,0,0]
    v_cvt_pk_bf16_f32 v92, v130, -v131
    v_pk_fma_f32 v[98:99], v[112:113], v[112:113], v[98:99] op_sel:[1,1,0] op_sel_hi:[1,0,1] neg_lo:[1,0,0]
    ds_write_b32 v48, v84 offset:2720
    ds_write_b32 v48, v87 offset:3264
    v_pk_fma_f32 v[110:111], v[108:109], v[112:113], v[110:111] op_sel:[1,1,0] op_sel_hi:[1,0,1] neg_lo:[1,0,0]
    v_cvt_pk_bf16_f32 v91, v118, -v119
    ds_write_b32 v48, v91 offset:18496
    ds_write_b32 v48, v92 offset:21760
    v_cvt_pk_bf16_f32 v82, v98, v99
    v_pk_mul_f32 v[100:101], v[102:103], v[112:113] op_sel_hi:[0,1]
    v_pk_mul_f32 v[104:105], v[106:107], v[112:113] op_sel_hi:[0,1]
    v_cvt_pk_bf16_f32 v89, v110, v111
    v_pk_mul_f32 v[120:121], v[118:119], v[72:73] op_sel_hi:[0,1]
    v_pk_fma_f32 v[120:121], v[118:119], v[72:73], v[120:121] op_sel:[1,1,0] op_sel_hi:[1,0,1] neg_lo:[1,0,0]
    v_pk_mul_f32 v[132:133], v[130:131], v[76:77] op_sel_hi:[0,1]
    ds_write_b32 v48, v82 offset:4352
    v_pk_fma_f32 v[100:101], v[102:103], v[112:113], v[100:101] op_sel:[1,1,0] op_sel_hi:[1,0,1] neg_lo:[1,0,0]
    v_pk_fma_f32 v[104:105], v[106:107], v[112:113], v[104:105] op_sel:[1,1,0] op_sel_hi:[1,0,1] neg_lo:[1,0,0]
    ds_write_b32 v48, v89 offset:3808
    v_cvt_pk_bf16_f32 v90, v120, -v121
    ds_write_b32 v48, v90 offset:19040
    v_pk_fma_f32 v[132:133], v[130:131], v[76:77], v[132:133] op_sel:[1,1,0] op_sel_hi:[1,0,1] neg_lo:[1,0,0]
    v_pk_mul_f32 v[96:97], v[98:99], v[112:113] op_sel_hi:[0,1]
    v_cvt_pk_bf16_f32 v85, v100, v101
    v_cvt_pk_bf16_f32 v86, v104, v105
    v_pk_mul_f32 v[108:109], v[110:111], v[112:113] op_sel_hi:[0,1]
    v_pk_mul_f32 v[122:123], v[120:121], v[72:73] op_sel_hi:[0,1]
    v_pk_fma_f32 v[122:123], v[120:121], v[72:73], v[122:123] op_sel:[1,1,0] op_sel_hi:[1,0,1] neg_lo:[1,0,0]
    v_cvt_pk_bf16_f32 v93, v132, -v133
    v_pk_fma_f32 v[96:97], v[98:99], v[112:113], v[96:97] op_sel:[1,1,0] op_sel_hi:[1,0,1] neg_lo:[1,0,0]
    ds_write_b32 v48, v85 offset:4896
    ds_write_b32 v48, v86 offset:5440
    v_pk_fma_f32 v[108:109], v[110:111], v[112:113], v[108:109] op_sel:[1,1,0] op_sel_hi:[1,0,1] neg_lo:[1,0,0]
    v_cvt_pk_bf16_f32 v91, v122, -v123
    ds_write_b32 v48, v91 offset:19584
    ds_write_b32 v48, v93 offset:23936
    v_cvt_pk_bf16_f32 v83, v96, v97
    v_pk_mul_f32 v[102:103], v[100:101], v[112:113] op_sel_hi:[0,1]
    v_pk_mul_f32 v[106:107], v[104:105], v[112:113] op_sel_hi:[0,1]
    v_cvt_pk_bf16_f32 v88, v108, v109
    v_pk_mul_f32 v[124:125], v[122:123], v[72:73] op_sel_hi:[0,1]
    v_pk_fma_f32 v[124:125], v[122:123], v[72:73], v[124:125] op_sel:[1,1,0] op_sel_hi:[1,0,1] neg_lo:[1,0,0]
    v_pk_mul_f32 v[130:131], v[132:133], v[76:77] op_sel_hi:[0,1]
    ds_write_b32 v48, v83 offset:6528
    v_pk_fma_f32 v[102:103], v[100:101], v[112:113], v[102:103] op_sel:[1,1,0] op_sel_hi:[1,0,1] neg_lo:[1,0,0]
    v_pk_fma_f32 v[106:107], v[104:105], v[112:113], v[106:107] op_sel:[1,1,0] op_sel_hi:[1,0,1] neg_lo:[1,0,0]
    ds_write_b32 v48, v88 offset:5984
    v_cvt_pk_bf16_f32 v90, v124, -v125
    ds_write_b32 v48, v90 offset:20128
    v_pk_fma_f32 v[130:131], v[132:133], v[76:77], v[130:131] op_sel:[1,1,0] op_sel_hi:[1,0,1] neg_lo:[1,0,0]
    v_pk_mul_f32 v[98:99], v[96:97], v[112:113] op_sel_hi:[0,1]
    v_cvt_pk_bf16_f32 v84, v102, v103
    v_cvt_pk_bf16_f32 v87, v106, v107
    v_pk_mul_f32 v[110:111], v[108:109], v[112:113] op_sel_hi:[0,1]
    v_pk_mul_f32 v[126:127], v[124:125], v[72:73] op_sel_hi:[0,1]
    v_pk_fma_f32 v[126:127], v[124:125], v[72:73], v[126:127] op_sel:[1,1,0] op_sel_hi:[1,0,1] neg_lo:[1,0,0]
    v_cvt_pk_bf16_f32 v92, v130, -v131
    v_pk_fma_f32 v[98:99], v[96:97], v[112:113], v[98:99] op_sel:[1,1,0] op_sel_hi:[1,0,1] neg_lo:[1,0,0]
    ds_write_b32 v48, v84 offset:7072
    ds_write_b32 v48, v87 offset:7616
    v_pk_fma_f32 v[110:111], v[108:109], v[112:113], v[110:111] op_sel:[1,1,0] op_sel_hi:[1,0,1] neg_lo:[1,0,0]
    v_cvt_pk_bf16_f32 v91, v126, -v127
    ds_write_b32 v48, v91 offset:20672
    ds_write_b32 v48, v92 offset:25024
    v_cvt_pk_bf16_f32 v82, v98, v99
    v_pk_mul_f32 v[100:101], v[102:103], v[112:113] op_sel_hi:[0,1]
    v_pk_mul_f32 v[104:105], v[106:107], v[112:113] op_sel_hi:[0,1]
    v_cvt_pk_bf16_f32 v89, v110, v111
    v_pk_mul_f32 v[128:129], v[126:127], v[72:73] op_sel_hi:[0,1]
    v_pk_fma_f32 v[128:129], v[126:127], v[72:73], v[128:129] op_sel:[1,1,0] op_sel_hi:[1,0,1] neg_lo:[1,0,0]
    v_pk_mul_f32 v[132:133], v[130:131], v[76:77] op_sel_hi:[0,1]
    ds_write_b32 v48, v82 offset:8704
    v_pk_fma_f32 v[100:101], v[102:103], v[112:113], v[100:101] op_sel:[1,1,0] op_sel_hi:[1,0,1] neg_lo:[1,0,0]
    v_pk_fma_f32 v[104:105], v[106:107], v[112:113], v[104:105] op_sel:[1,1,0] op_sel_hi:[1,0,1] neg_lo:[1,0,0]
    ds_write_b32 v48, v89 offset:8160
    v_cvt_pk_bf16_f32 v90, v128, -v129
    ds_write_b32 v48, v90 offset:21216
    v_pk_fma_f32 v[132:133], v[130:131], v[76:77], v[132:133] op_sel:[1,1,0] op_sel_hi:[1,0,1] neg_lo:[1,0,0]
    v_pk_mul_f32 v[96:97], v[98:99], v[112:113] op_sel_hi:[0,1]
    v_cvt_pk_bf16_f32 v85, v100, v101
    v_cvt_pk_bf16_f32 v86, v104, v105
    v_pk_mul_f32 v[108:109], v[110:111], v[112:113] op_sel_hi:[0,1]
    v_pk_mul_f32 v[134:135], v[118:119], v[76:77] op_sel_hi:[0,1]
    v_pk_fma_f32 v[134:135], v[118:119], v[76:77], v[134:135] op_sel:[1,1,0] op_sel_hi:[1,0,1] neg_lo:[1,0,0]
    v_cvt_pk_bf16_f32 v93, v132, -v133
    v_pk_fma_f32 v[96:97], v[98:99], v[112:113], v[96:97] op_sel:[1,1,0] op_sel_hi:[1,0,1] neg_lo:[1,0,0]
    ds_write_b32 v48, v85 offset:9248
    ds_write_b32 v48, v86 offset:9792
    v_pk_fma_f32 v[108:109], v[110:111], v[112:113], v[108:109] op_sel:[1,1,0] op_sel_hi:[1,0,1] neg_lo:[1,0,0]
    v_cvt_pk_bf16_f32 v91, v134, -v135
    ds_write_b32 v48, v91 offset:22304
    ds_write_b32 v48, v93 offset:26112
    v_cvt_pk_bf16_f32 v83, v96, v97
    v_pk_mul_f32 v[102:103], v[100:101], v[112:113] op_sel_hi:[0,1]
    v_pk_mul_f32 v[106:107], v[104:105], v[112:113] op_sel_hi:[0,1]
    v_cvt_pk_bf16_f32 v88, v108, v109
    v_pk_mul_f32 v[136:137], v[122:123], v[76:77] op_sel_hi:[0,1]
    v_pk_fma_f32 v[136:137], v[122:123], v[76:77], v[136:137] op_sel:[1,1,0] op_sel_hi:[1,0,1] neg_lo:[1,0,0]
    v_pk_mul_f32 v[130:131], v[132:133], v[76:77] op_sel_hi:[0,1]
    ds_write_b32 v48, v83 offset:10880
    v_pk_fma_f32 v[102:103], v[100:101], v[112:113], v[102:103] op_sel:[1,1,0] op_sel_hi:[1,0,1] neg_lo:[1,0,0]
    v_pk_fma_f32 v[106:107], v[104:105], v[112:113], v[106:107] op_sel:[1,1,0] op_sel_hi:[1,0,1] neg_lo:[1,0,0]
    ds_write_b32 v48, v88 offset:10336
    v_cvt_pk_bf16_f32 v90, v136, -v137
    ds_write_b32 v48, v90 offset:22848
    v_pk_fma_f32 v[130:131], v[132:133], v[76:77], v[130:131] op_sel:[1,1,0] op_sel_hi:[1,0,1] neg_lo:[1,0,0]
    v_pk_mul_f32 v[98:99], v[96:97], v[112:113] op_sel_hi:[0,1]
    v_cvt_pk_bf16_f32 v84, v102, v103
    v_cvt_pk_bf16_f32 v87, v106, v107
    v_pk_mul_f32 v[110:111], v[108:109], v[112:113] op_sel_hi:[0,1]
    v_pk_mul_f32 v[138:139], v[126:127], v[76:77] op_sel_hi:[0,1]
    v_pk_fma_f32 v[138:139], v[126:127], v[76:77], v[138:139] op_sel:[1,1,0] op_sel_hi:[1,0,1] neg_lo:[1,0,0]
    v_cvt_pk_bf16_f32 v92, v130, -v131
    v_pk_fma_f32 v[98:99], v[96:97], v[112:113], v[98:99] op_sel:[1,1,0] op_sel_hi:[1,0,1] neg_lo:[1,0,0]
    ds_write_b32 v48, v84 offset:11424
    ds_write_b32 v48, v87 offset:11968
    v_pk_fma_f32 v[110:111], v[108:109], v[112:113], v[110:111] op_sel:[1,1,0] op_sel_hi:[1,0,1] neg_lo:[1,0,0]
    v_cvt_pk_bf16_f32 v91, v138, -v139
    ds_write_b32 v48, v91 offset:23392
    ds_write_b32 v48, v92 offset:26656
    v_cvt_pk_bf16_f32 v82, v98, v99
    v_pk_mul_f32 v[100:101], v[102:103], v[112:113] op_sel_hi:[0,1]
    v_pk_mul_f32 v[104:105], v[106:107], v[112:113] op_sel_hi:[0,1]
    v_cvt_pk_bf16_f32 v89, v110, v111
    v_pk_mul_f32 v[134:135], v[136:137], v[76:77] op_sel_hi:[0,1]
    v_pk_fma_f32 v[134:135], v[136:137], v[76:77], v[134:135] op_sel:[1,1,0] op_sel_hi:[1,0,1] neg_lo:[1,0,0]
    v_pk_mul_f32 v[132:133], v[130:131], v[76:77] op_sel_hi:[0,1]
    ds_write_b32 v48, v82 offset:13056
    v_pk_fma_f32 v[100:101], v[102:103], v[112:113], v[100:101] op_sel:[1,1,0] op_sel_hi:[1,0,1] neg_lo:[1,0,0]
    v_pk_fma_f32 v[104:105], v[106:107], v[112:113], v[104:105] op_sel:[1,1,0] op_sel_hi:[1,0,1] neg_lo:[1,0,0]
    ds_write_b32 v48, v89 offset:12512
    v_cvt_pk_bf16_f32 v90, v134, -v135
    ds_write_b32 v48, v90 offset:24480
    v_pk_fma_f32 v[132:133], v[130:131], v[76:77], v[132:133] op_sel:[1,1,0] op_sel_hi:[1,0,1] neg_lo:[1,0,0]
    v_pk_mul_f32 v[96:97], v[98:99], v[112:113] op_sel_hi:[0,1]
    v_cvt_pk_bf16_f32 v85, v100, v101
    v_cvt_pk_bf16_f32 v86, v104, v105
    v_pk_mul_f32 v[108:109], v[110:111], v[112:113] op_sel_hi:[0,1]
    v_pk_mul_f32 v[138:139], v[134:135], v[76:77] op_sel_hi:[0,1]
    v_pk_fma_f32 v[138:139], v[134:135], v[76:77], v[138:139] op_sel:[1,1,0] op_sel_hi:[1,0,1] neg_lo:[1,0,0]
    v_cvt_pk_bf16_f32 v93, v132, -v133
    v_pk_fma_f32 v[96:97], v[98:99], v[112:113], v[96:97] op_sel:[1,1,0] op_sel_hi:[1,0,1] neg_lo:[1,0,0]
    ds_write_b32 v48, v85 offset:13600
    ds_write_b32 v48, v86 offset:14144
    v_pk_fma_f32 v[108:109], v[110:111], v[112:113], v[108:109] op_sel:[1,1,0] op_sel_hi:[1,0,1] neg_lo:[1,0,0]
    v_cvt_pk_bf16_f32 v91, v138, -v139
    ds_write_b32 v48, v91 offset:25568
    ds_write_b32 v48, v93 offset:27200
    v_cvt_pk_bf16_f32 v83, v96, v97
    v_pk_mul_f32 v[102:103], v[100:101], v[112:113] op_sel_hi:[0,1]
    v_pk_mul_f32 v[106:107], v[104:105], v[112:113] op_sel_hi:[0,1]
    v_cvt_pk_bf16_f32 v88, v108, v109
    v_pk_mul_f32 v[130:131], v[132:133], v[76:77] op_sel_hi:[0,1]
    ds_write_b32 v48, v83 offset:15232
    v_pk_fma_f32 v[102:103], v[100:101], v[112:113], v[102:103] op_sel:[1,1,0] op_sel_hi:[1,0,1] neg_lo:[1,0,0]
    v_pk_fma_f32 v[106:107], v[104:105], v[112:113], v[106:107] op_sel:[1,1,0] op_sel_hi:[1,0,1] neg_lo:[1,0,0]
    ds_write_b32 v48, v88 offset:14688
    v_pk_fma_f32 v[130:131], v[132:133], v[76:77], v[130:131] op_sel:[1,1,0] op_sel_hi:[1,0,1] neg_lo:[1,0,0]
    v_cvt_pk_bf16_f32 v84, v102, v103
    v_cvt_pk_bf16_f32 v87, v106, v107
    v_pk_mul_f32 v[110:111], v[108:109], v[112:113] op_sel_hi:[0,1]
    v_cvt_pk_bf16_f32 v92, v130, -v131
    ds_write_b32 v48, v84 offset:15776
    ds_write_b32 v48, v87 offset:16320
    v_pk_fma_f32 v[110:111], v[108:109], v[112:113], v[110:111] op_sel:[1,1,0] op_sel_hi:[1,0,1] neg_lo:[1,0,0]
    ds_write_b32 v48, v92 offset:27744
    v_cvt_pk_bf16_f32 v89, v110, v111
    v_pk_mul_f32 v[132:133], v[130:131], v[76:77] op_sel_hi:[0,1]
    ds_write_b32 v48, v89 offset:16864
    v_pk_fma_f32 v[132:133], v[130:131], v[76:77], v[132:133] op_sel:[1,1,0] op_sel_hi:[1,0,1] neg_lo:[1,0,0]
    v_cvt_pk_bf16_f32 v93, v132, -v133
    ds_write_b32 v48, v93 offset:28288
    v_lshrrev_b32 v1, 3, v0
    v_and_b32 v2, 7, v0
    v_mul_u32_u24 v3, 11520, v1
    v_lshl_add_u32 v22, v2, 4, v3
    v_min_u32_e64 v4, 5, v2
    v_lshl_add_u32 v23, v4, 4, v3
    v_mul_u32_u24_e64 v4, 12, v2
    v_lshl_add_u32 v24, v1, 7, v4
    v_sub_u32 v4, 2, v2
    v_ashrrev_i32 v4, 31, v4
    v_and_b32 v4, 4092, v4
    v_add_u32_e64 v25, v4, v24
    s_mul_i32 s11, s9, 368640
    s_mul_i32 s12, s19, 352
    s_add_u32 s36, s11, s12
    s_and_b32 s12, s19, 28
    s_lshl_b32 s12, s12, 2
    s_add_u32 s36, s36, s12
    s_add_u32 s36, s36, 4096
    v_and_b32_e64 v42, 15, v0
    v_bfe_u32 v43, v0, 4, 2
    s_mul_i32 s11, s17, 28832
    s_add_u32 s11, s11, 8448
    v_mul_u32_u24 v1, 544, v42
    v_lshl_add_u32 v1, v43, 4, v1
    v_add_u32_e64 v27, s11, v1
    s_mul_i32 s12, s18, 8704
    v_add_u32_e64 v26, s12, v27
    s_waitcnt lgkmcnt(0)
    s_barrier
    ds_read_b128 v[32:35], v26 offset:0
    ds_read_b128 v[98:101], v27 offset:17408
    ds_read_b128 v[130:133], v27 offset:26112
    ds_read_b128 v[36:39], v26 offset:64
    ds_read_b128 v[102:105], v27 offset:17472
    ds_read_b128 v[134:137], v27 offset:26176
    ds_read_b128 v[74:77], v26 offset:128
    ds_read_b128 v[106:109], v27 offset:17536
    ds_read_b128 v[138:141], v27 offset:26240
    ds_read_b128 v[78:81], v26 offset:192
    ds_read_b128 v[110:113], v27 offset:17600
    ds_read_b128 v[142:145], v27 offset:26304
    s_waitcnt vmcnt(0)
    buffer_load_dwordx4 v[62:65], v22, s[4:7], s36 offen offset:0 sc1
    buffer_load_dwordx4 v[66:69], v22, s[4:7], s36 offen offset:128 sc1
    buffer_load_dwordx4 v[70:73], v23, s[4:7], s36 offen offset:256 sc1
    s_waitcnt lgkmcnt(10)
    v_mfma_f32_16x16x32_bf16 v[162:165], v[98:101], v[32:35], 0
    s_waitcnt lgkmcnt(9)
    v_mfma_f32_16x16x32_bf16 v[166:169], v[130:133], v[32:35], 0
    ds_read_b128 v[82:85], v26 offset:256
    ds_read_b128 v[114:117], v27 offset:17664
    ds_read_b128 v[146:149], v27 offset:26368
    s_lshl_b32 s11, s18, 4
    v_add_u32_e64 v3, s11, v42
    s_mul_i32 s11, s17, 3104
    s_add_u32 s11, s11, 66128
    s_waitcnt lgkmcnt(10)
    v_mfma_f32_16x16x32_bf16 v[162:165], v[102:105], v[36:39], v[162:165]
    s_waitcnt lgkmcnt(9)
    v_mfma_f32_16x16x32_bf16 v[166:169], v[134:137], v[36:39], v[166:169]
    ds_read_b128 v[86:89], v26 offset:320
    ds_read_b128 v[118:121], v27 offset:17728
    ds_read_b128 v[150:153], v27 offset:26432
    v_lshlrev_b32_e64 v1, 3, v3
    v_lshl_add_u32 v1, v43, 2, v1
    v_lshlrev_b32_e64 v2, 2, v3
    v_add_u32 v2, 256, v2
    s_waitcnt lgkmcnt(10)
    v_mfma_f32_16x16x32_bf16 v[162:165], v[106:109], v[74:77], v[162:165]
    s_waitcnt lgkmcnt(9)
    v_mfma_f32_16x16x32_bf16 v[166:169], v[138:141], v[74:77], v[166:169]
    ds_read_b128 v[90:93], v26 offset:384
    ds_read_b128 v[122:125], v27 offset:17792
    ds_read_b128 v[154:157], v27 offset:26496
    v_cmp_eq_u32 s[46:47], 2, v43
    v_add_u32_e64 v29, v3, v3
    v_add_u32 v29, 384, v29
    v_cndmask_b32 v1, v1, v2, s[46:47]
    s_waitcnt lgkmcnt(10)
    v_mfma_f32_16x16x32_bf16 v[162:165], v[110:113], v[78:81], v[162:165]
    s_waitcnt lgkmcnt(9)
    v_mfma_f32_16x16x32_bf16 v[166:169], v[142:145], v[78:81], v[166:169]
    ds_read_b128 v[94:97], v26 offset:448
    ds_read_b128 v[126:129], v27 offset:17856
    ds_read_b128 v[158:161], v27 offset:26560
    v_cmp_eq_u32 s[46:47], 3, v43
    v_lshl_add_u32 v30, v43, 7, v3
    v_add_u32 v30, 512, v30
    v_cndmask_b32 v2, 2, 64, s[46:47]
    s_waitcnt lgkmcnt(10)
    v_mfma_f32_16x16x32_bf16 v[162:165], v[114:117], v[82:85], v[162:165]
    s_waitcnt lgkmcnt(9)
    v_mfma_f32_16x16x32_bf16 v[166:169], v[146:149], v[82:85], v[166:169]
    v_cndmask_b32 v1, v1, v29, s[46:47]
    v_lshl_add_u32 v28, v1, 2, s11
    v_lshl_add_u32 v30, v30, 2, s11
    v_lshl_add_u32 v29, v2, 2, v28
    s_waitcnt lgkmcnt(7)
    v_mfma_f32_16x16x32_bf16 v[162:165], v[118:121], v[86:89], v[162:165]
    s_waitcnt lgkmcnt(6)
    v_mfma_f32_16x16x32_bf16 v[166:169], v[150:153], v[86:89], v[166:169]
    v_mov_b64 v[170:171], 0
    v_mov_b64 v[172:173], 0
    v_lshlrev_b32_e64 v1, 3, v0
    v_lshrrev_b32 v2, 2, v21
    s_waitcnt lgkmcnt(4)
    v_mfma_f32_16x16x32_bf16 v[162:165], v[122:125], v[90:93], v[162:165]
    s_waitcnt lgkmcnt(3)
    v_mfma_f32_16x16x32_bf16 v[166:169], v[154:157], v[90:93], v[166:169]
    v_add_u32 v2, 128, v2
    v_min_u32 v1, v1, v2
    v_add_u32_e64 v2, v0, v0
    v_add_u32 v2, 256, v2
    s_waitcnt lgkmcnt(1)
    v_mfma_f32_16x16x32_bf16 v[162:165], v[126:129], v[94:97], v[162:165]
    s_waitcnt lgkmcnt(0)
    v_mfma_f32_16x16x32_bf16 v[166:169], v[158:161], v[94:97], v[166:169]
    v_add_u32 v3, 384, v0
    v_min3_u32 v1, v1, v2, v3
    v_lshlrev_b32_e64 v1, 2, v1
    v_add_u32 v44, 66128, v1
    s_nop 1
    ds_write_b64 v28, v[162:163]
    ds_write_b64 v29, v[164:165]
    s_mov_b32 exec_hi, 0
    ds_write_b32 v30, v166 offset:0
    ds_write_b32 v30, v167 offset:128
    ds_write_b32 v30, v168 offset:256
    ds_write_b32 v30, v169 offset:384
    s_mov_b64 exec, 1
    s_nop 0
    v_mov_b32 v3, 66112
    ds_write_b128 v3, v[170:173]
    ds_write_b128 v3, v[170:173] offset:3104
    s_mov_b64 exec, 0xff
    v_and_b32 v3, 0x70, v21
    ds_write_b128 v3, v[170:173] offset:0
    ds_write_b128 v3, v[170:173] offset:4224
    s_mov_b64 exec, -1
    v_lshrrev_b32 v3, 3, v0
    v_lshlrev_b32 v3, 4, v3
    v_add_u32 v31, v3, v21
    v_sub_u32 v3, v0, 33
    v_ashrrev_i32_e64 v3, 31, v3
    v_lshl_add_u32 v45, v3, 2, v44
    s_lshr_b32 s55, s54, 16
    s_lshl_b32 s55, s55, 16
    s_lshl_b32 s54, s54, 16
    s_waitcnt lgkmcnt(0)
    s_barrier
    s_cmp_ge_u32 s10, 2
    s_cbranch_scc1 L_sg3
    s_cmp_eq_u32 s10, 1
    s_cbranch_scc1 L_sg2
    s_nop 0
    ds_read_b128 v[32:35], v44 offset:0
    ds_read_b128 v[36:39], v44 offset:16
    ds_read_b32 v48, v45 offset:0
    ds_read_b128 v[74:77], v44 offset:3104
    ds_read_b128 v[78:81], v44 offset:3120
    ds_read_b32 v49, v45 offset:3104
    s_mov_b64 exec, 1
    ds_write_b128 v170, v[170:173] offset:8560
    ds_write_b128 v170, v[170:173] offset:13360
    ds_write_b128 v170, v[170:173] offset:18160
    ds_write_b128 v170, v[170:173] offset:22960
    s_waitcnt lgkmcnt(9)
    v_add_f32 v32, s54, v32
    s_waitcnt lgkmcnt(6)
    v_add_f32 v74, s55, v74
    s_mov_b32 exec_lo, 0
    s_mov_b32 exec_hi, -1
    v_mov_b32 v39, v36
    v_mov_b32 v38, v35
    v_mov_b32 v37, v34
    v_mov_b32 v36, v34
    v_mov_b32 v35, v34
    v_mov_b32 v34, v33
    v_mov_b32 v33, v32
    s_waitcnt lgkmcnt(5)
    v_mov_b32 v81, v78
    v_mov_b32 v80, v77
    v_mov_b32 v79, v76
    v_mov_b32 v78, v76
    v_mov_b32 v77, v76
    v_mov_b32_e64 v76, v75
    v_mov_b32 v75, v74
    s_mov_b64 exec, -1
    v_cvt_pk_bf16_f32 v82, v32, v33
    v_cvt_pk_bf16_f32 v90, v48, v32
    v_cvt_pk_bf16_f32 v83, v34, v35
    v_cvt_pk_bf16_f32 v91, v33, v34
    v_cvt_pk_bf16_f32 v84, v36, v37
    v_cvt_pk_bf16_f32 v92, v35, v36
    v_cvt_pk_bf16_f32 v85, v38, v39
    v_cvt_pk_bf16_f32 v93, v37, v38
    ds_write_b128 v31, v[82:85] offset:8592
    ds_write_b128 v31, v[90:93] offset:13392
    v_cvt_pk_bf16_f32 v86, v74, v75
    s_waitcnt lgkmcnt(6)
    s_nop 0
    v_cvt_pk_bf16_f32 v94, v49, v74
    v_cvt_pk_bf16_f32 v87, v76, v77
    v_cvt_pk_bf16_f32 v95, v75, v76
    v_cvt_pk_bf16_f32 v88, v78, v79
    v_cvt_pk_bf16_f32 v96, v77, v78
    v_cvt_pk_bf16_f32 v89, v80, v81
    v_cvt_pk_bf16_f32 v97, v79, v80
    ds_write_b128 v31, v[86:89] offset:18192
    ds_write_b128 v31, v[94:97] offset:22992
    s_branch L_sgd
L_sg2:
    ds_read_b64 v[32:33], v44 offset:0
    ds_read_b32 v34, v44 offset:8
    ds_read_b64 v[74:75], v44 offset:3104
    ds_read_b32 v76, v44 offset:3112
    s_waitcnt lgkmcnt(3)
    v_cvt_pk_bf16_f32 v82, v32, v32
    v_cvt_pk_bf16_f32 v90, v32, v32
    v_cvt_pk_bf16_f32 v83, v32, v33
    v_cvt_pk_bf16_f32 v91, v32, v32
    v_cvt_pk_bf16_f32 v84, v33, v33
    v_cvt_pk_bf16_f32 v92, v33, v33
    s_waitcnt lgkmcnt(2)
    v_cvt_pk_bf16_f32 v85, v34, v34
    v_cvt_pk_bf16_f32 v93, v33, v34
    ds_write_b128 v31, v[82:85] offset:8592
    ds_write_b128 v31, v[90:93] offset:13392
    s_waitcnt lgkmcnt(3)
    v_cvt_pk_bf16_f32 v86, v74, v74
    v_cvt_pk_bf16_f32 v94, v74, v74
    v_cvt_pk_bf16_f32 v87, v74, v75
    v_cvt_pk_bf16_f32 v95, v74, v74
    v_cvt_pk_bf16_f32 v88, v75, v75
    v_cvt_pk_bf16_f32 v96, v75, v75
    s_waitcnt lgkmcnt(2)
    v_cvt_pk_bf16_f32 v89, v76, v76
    v_cvt_pk_bf16_f32 v97, v75, v76
    ds_write_b128 v31, v[86:89] offset:18192
    ds_write_b128 v31, v[94:97] offset:22992
    s_branch L_sgd
L_sg3:
    ds_read_b32 v32, v44 offset:0
    ds_read_b32 v33, v44 offset:4
    ds_read_b32 v74, v44 offset:3104
    ds_read_b32 v75, v44 offset:3108
    s_mov_b32 s40, 0xaaaaaaaa
    s_mov_b32 s41, 0xaaaaaaaa
    s_waitcnt lgkmcnt(2)
    s_nop 0
    v_cndmask_b32 v34, v32, v33, s[40:41]
    v_cvt_pk_bf16_f32 v82, v32, v32
    v_cvt_pk_bf16_f32 v90, v32, v32
    v_cvt_pk_bf16_f32 v83, v32, v32
    v_cvt_pk_bf16_f32 v91, v32, v32
    v_cvt_pk_bf16_f32 v84, v34, v33
    v_cvt_pk_bf16_f32 v92, v32, v34
    v_cvt_pk_bf16_f32 v85, v33, v33
    v_cvt_pk_bf16_f32 v93, v33, v33
    ds_write_b128 v31, v[82:85] offset:8592
    ds_write_b128 v31, v[90:93] offset:13392
    s_waitcnt lgkmcnt(2)
    s_nop 0
    v_cndmask_b32 v76, v74, v75, s[40:41]
    v_cvt_pk_bf16_f32 v86, v74, v74
    v_cvt_pk_bf16_f32 v94, v74, v74
    v_cvt_pk_bf16_f32 v87, v74, v74
    v_cvt_pk_bf16_f32 v95, v74, v74
    v_cvt_pk_bf16_f32 v88, v76, v75
    v_cvt_pk_bf16_f32 v96, v74, v76
    v_cvt_pk_bf16_f32 v89, v75, v75
    v_cvt_pk_bf16_f32 v97, v75, v75
    ds_write_b128 v31, v[86:89] offset:18192
    ds_write_b128 v31, v[94:97] offset:22992
L_sgd:
    v_and_b32_e64 v1, 3, v0
    v_bfe_u32 v2, v0, 4, 1
    v_lshl_add_u32 v1, v2, 2, v1
    v_bfe_u32 v3, v0, 2, 2
    v_bfe_u32 v4, v0, 5, 1
    v_lshrrev_b32_e64 v18, 1, v1
    v_lshl_add_u32 v18, v4, 2, v18
    v_add_u32 v18, -3, v18
    v_and_b32 v2, 1, v1
    v_sub_u32_e64 v2, 1, v2
    v_mul_u32_u24 v2, 4800, v2
    v_mul_u32_u24 v19, 144, v3
    s_mul_i32 s11, s17, 9600
    s_add_u32 s11, s11, 8592
    v_add3_u32 v2, v2, v19, s11
    v_lshl_add_u32 v6, v18, 2, v2
    v_add_u32 v20, 0, v18
    v_ashrrev_i32 v19, 31, v20
    v_lshl_add_u32 v20, v19, 2, v20
    v_lshl_add_u32 v14, v20, 2, v2
    v_add_u32 v20, 1, v18
    v_ashrrev_i32 v19, 31, v20
    v_lshl_add_u32 v20, v19, 2, v20
    v_lshl_add_u32 v15, v20, 2, v2
    v_add_u32 v20, 2, v18
    v_ashrrev_i32 v19, 31, v20
    v_lshl_add_u32 v20, v19, 2, v20
    v_lshl_add_u32 v16, v20, 2, v2
    v_add_u32 v20, 3, v18
    v_ashrrev_i32 v19, 31, v20
    v_lshl_add_u32 v20, v19, 2, v20
    v_lshl_add_u32 v17, v20, 2, v2
    v_and_b32 v18, 31, v0
    v_sub_u32 v18, v18, v4
    s_mul_i32 s11, s17, 4224
    s_add_u32 s11, s11, 32
    v_lshl_add_u32 v18, v18, 4, s11
    s_waitcnt vmcnt(0)
    v_xor_b32 v2, v5, v65
    v_xor_b32 v69, v5, v69
    v_xor_b32_e64 v73, v5, v73
    v_or3_b32 v2, v2, v69, v73
    v_cmpx_ne_u32 vcc, 0, v2
    s_nop 0
    s_cbranch_execnz L_rty12
L_got11:
    s_mov_b64 exec, -1
    ds_write2_b32 v24, v62, v63 offset0:32 offset1:33
    ds_write_b32 v24, v64 offset:136
    ds_write2_b32 v25, v66, v67 offset0:56 offset1:57
    s_mov_b32 exec_lo, 0xfbfbfbfb
    s_mov_b32 exec_hi, 0xfbfbfbfb
    ds_write_b32 v25, v68 offset:232
    s_mov_b32 exec_lo, 0x3f3f3f3f
    s_mov_b32 exec_hi, 0x3f3f3f3f
    ds_write_b32 v24, v70 offset:4412
    ds_write_b32 v24, v71 offset:4416
    s_mov_b32 exec_lo, 0x1f1f1f1f
    s_mov_b32 exec_hi, 0x1f1f1f1f
    ds_write_b32 v24, v72 offset:4420
    s_mov_b64 exec, -1
    s_nop 0
    v_add_u32 v7, 576, v6
    v_add_u32 v8, 1152, v6
    v_add_u32 v9, 1728, v6
    v_add_u32 v10, 2304, v6
    v_add_u32 v11, 2880, v6
    v_add_u32 v12, 3456, v6
    v_add_u32 v13, 4032, v6
    s_waitcnt lgkmcnt(0)
    s_barrier
    s_setprio 0
    s_cmp_eq_u32 s18, 1
    s_cbranch_scc1 L_cvb
    s_nop 0
    ds_read_b128 v[86:89], v18 offset:64
    ds_read2_b32 v[150:151], v6 offset0:8 offset1:9
    ds_read2_b32 v[152:153], v6 offset0:10 offset1:11
    ds_read_b128 v[90:93], v18 offset:576
    ds_read2_b32 v[154:155], v7 offset0:8 offset1:9
    ds_read2_b32 v[156:157], v7 offset0:10 offset1:11
    ds_read_b128 v[94:97], v18 offset:1088
    ds_read2_b32 v[158:159], v8 offset0:8 offset1:9
    ds_read2_b32 v[160:161], v8 offset0:10 offset1:11
    ds_read_b128 v[98:101], v18 offset:1600
    ds_read2_b32 v[162:163], v9 offset0:8 offset1:9
    ds_read2_b32 v[164:165], v9 offset0:10 offset1:11
    s_waitcnt lgkmcnt(9)
    s_nop 0
    v_mfma_f32_32x32x16_bf16 v[22:37], v[86:89], v[150:153], 0
    ds_read_b128 v[102:105], v18 offset:2112
    ds_read2_b32 v[166:167], v10 offset0:8 offset1:9
    ds_read2_b32 v[168:169], v10 offset0:10 offset1:11
    ds_read_b128 v[106:109], v18 offset:2624
    ds_read2_b32 v[170:171], v11 offset0:8 offset1:9
    ds_read2_b32 v[172:173], v11 offset0:10 offset1:11
    s_waitcnt lgkmcnt(11)
    v_mfma_f32_32x32x16_bf16 v[38:53], v[94:97], v[154:157], 0
    s_waitcnt lgkmcnt(9)
    v_mfma_f32_32x32x16_bf16 v[38:53], v[90:93], v[158:161], v[38:53]
    v_mfma_f32_32x32x16_bf16 v[54:69], v[94:97], v[158:161], 0
    ds_read_b128 v[110:113], v18 offset:3136
    ds_read2_b32 v[174:175], v12 offset0:8 offset1:9
    ds_read2_b32 v[176:177], v12 offset0:10 offset1:11
    s_waitcnt lgkmcnt(11)
    v_mfma_f32_32x32x16_bf16 v[38:53], v[98:101], v[150:153], v[38:53]
    s_waitcnt lgkmcnt(9)
    v_mfma_f32_32x32x16_bf16 v[38:53], v[86:89], v[162:165], v[38:53]
    v_mfma_f32_32x32x16_bf16 v[54:69], v[98:101], v[154:157], v[54:69]
    v_mfma_f32_32x32x16_bf16 v[54:69], v[90:93], v[162:165], v[54:69]
    ds_read_b128 v[114:117], v18 offset:3648
    ds_read2_b32 v[178:179], v13 offset0:8 offset1:9
    ds_read2_b32 v[180:181], v13 offset0:10 offset1:11
    s_waitcnt lgkmcnt(11)
    s_nop 0
    v_mfma_f32_32x32x16_bf16 v[54:69], v[102:105], v[150:153], v[54:69]
    ds_read_b128 v[118:121], v18 offset:96
    ds_read_b32 v182, v14 offset:0
    ds_read_b32 v183, v15 offset:0
    ds_read_b32 v184, v16 offset:0
    ds_read_b32 v185, v17 offset:0
    s_waitcnt lgkmcnt(14)
    s_nop 0
    v_mfma_f32_32x32x16_bf16 v[54:69], v[86:89], v[166:169], v[54:69]
    ds_read_b128 v[122:125], v18 offset:608
    ds_read_b32 v186, v14 offset:576
    ds_read_b32 v187, v15 offset:576
    ds_read_b32 v188, v16 offset:576
    ds_read_b32 v189, v17 offset:576
    v_mfma_f32_32x32x16_bf16 v[70:85], v[102:105], v[162:165], 0
    ds_read_b128 v[126:129], v18 offset:1120
    ds_read_b32 v190, v14 offset:1152
    ds_read_b32 v191, v15 offset:1152
    ds_read_b32 v192, v16 offset:1152
    ds_read_b32 v193, v17 offset:1152
    v_mfma_f32_32x32x16_bf16 v[70:85], v[98:101], v[166:169], v[70:85]
    ds_read_b128 v[130:133], v18 offset:1632
    ds_read_b32 v194, v14 offset:1728
    ds_read_b32 v195, v15 offset:1728
    ds_read_b32 v196, v16 offset:1728
    ds_read_b32 v197, v17 offset:1728
    s_waitcnt lgkmcnt(15)
    s_nop 0
    v_mfma_f32_32x32x16_bf16 v[70:85], v[106:109], v[158:161], v[70:85]
    ds_read_b128 v[134:137], v18 offset:2144
    ds_read_b32 v198, v14 offset:2304
    ds_read_b32 v199, v15 offset:2304
    ds_read_b32 v200, v16 offset:2304
    v_mfma_f32_32x32x16_bf16 v[70:85], v[94:97], v[170:173], v[70:85]
    ds_read_b32 v201, v17 offset:2304
    ds_read_b128 v[138:141], v18 offset:2656
    ds_read_b32 v202, v14 offset:2880
    ds_read_b32 v203, v15 offset:2880
    v_mfma_f32_32x32x16_bf16 v[70:85], v[110:113], v[154:157], v[70:85]
    ds_read_b32 v204, v16 offset:2880
    ds_read_b32 v205, v17 offset:2880
    ds_read_b128 v[142:145], v18 offset:3168
    ds_read_b32 v206, v14 offset:3456
    v_mfma_f32_32x32x16_bf16 v[70:85], v[90:93], v[174:177], v[70:85]
    ds_read_b32 v207, v15 offset:3456
    ds_read_b32 v208, v16 offset:3456
    ds_read_b32 v209, v17 offset:3456
    ds_read_b128 v[146:149], v18 offset:3680
    v_mfma_f32_32x32x16_bf16 v[70:85], v[114:117], v[150:153], v[70:85]
    ds_read_b32 v210, v14 offset:4032
    ds_read_b32 v211, v15 offset:4032
    ds_read_b32 v212, v16 offset:4032
    ds_read_b32 v213, v17 offset:4032
    v_mfma_f32_32x32x16_bf16 v[70:85], v[86:89], v[178:181], v[70:85]
    v_mfma_f32_32x32x16_bf16 v[22:37], v[118:121], v[182:185], v[22:37]
    s_waitcnt lgkmcnt(15)
    s_nop 0
    v_mfma_f32_32x32x16_bf16 v[38:53], v[130:133], v[182:185], v[38:53]
    ds_read_b128 v[86:89], v18 offset:32
    ds_read2_b32 v[150:151], v6 offset0:16 offset1:17
    v_mfma_f32_32x32x16_bf16 v[38:53], v[126:129], v[186:189], v[38:53]
    ds_read2_b32 v[152:153], v6 offset0:18 offset1:19
    ds_read_b128 v[90:93], v18 offset:544
    v_mfma_f32_32x32x16_bf16 v[38:53], v[122:125], v[190:193], v[38:53]
    ds_read2_b32 v[154:155], v7 offset0:16 offset1:17
    ds_read2_b32 v[156:157], v7 offset0:18 offset1:19
    v_mfma_f32_32x32x16_bf16 v[38:53], v[118:121], v[194:197], v[38:53]
    ds_read_b128 v[94:97], v18 offset:1056
    ds_read2_b32 v[158:159], v8 offset0:16 offset1:17
    v_mfma_f32_32x32x16_bf16 v[54:69], v[134:137], v[182:185], v[54:69]
    ds_read2_b32 v[160:161], v8 offset0:18 offset1:19
    ds_read_b128 v[98:101], v18 offset:1568
    v_mfma_f32_32x32x16_bf16 v[54:69], v[130:133], v[186:189], v[54:69]
    ds_read2_b32 v[162:163], v9 offset0:16 offset1:17
    ds_read2_b32 v[164:165], v9 offset0:18 offset1:19
    v_mfma_f32_32x32x16_bf16 v[54:69], v[126:129], v[190:193], v[54:69]
    ds_read_b128 v[102:105], v18 offset:2080
    ds_read2_b32 v[166:167], v10 offset0:16 offset1:17
    v_mfma_f32_32x32x16_bf16 v[54:69], v[122:125], v[194:197], v[54:69]
    ds_read2_b32 v[168:169], v10 offset0:18 offset1:19
    ds_read_b128 v[106:109], v18 offset:2592
    v_mfma_f32_32x32x16_bf16 v[54:69], v[118:121], v[198:201], v[54:69]
    ds_read2_b32 v[170:171], v11 offset0:16 offset1:17
    ds_read2_b32 v[172:173], v11 offset0:18 offset1:19
    s_waitcnt lgkmcnt(15)
    s_nop 0
    v_mfma_f32_32x32x16_bf16 v[70:85], v[146:149], v[182:185], v[70:85]
    ds_read_b128 v[110:113], v18 offset:3104
    ds_read2_b32 v[174:175], v12 offset0:16 offset1:17
    v_mfma_f32_32x32x16_bf16 v[70:85], v[142:145], v[186:189], v[70:85]
    ds_read2_b32 v[176:177], v12 offset0:18 offset1:19
    ds_read_b128 v[114:117], v18 offset:3616
    v_mfma_f32_32x32x16_bf16 v[70:85], v[138:141], v[190:193], v[70:85]
    ds_read2_b32 v[178:179], v13 offset0:16 offset1:17
    ds_read2_b32 v[180:181], v13 offset0:18 offset1:19
    v_mfma_f32_32x32x16_bf16 v[70:85], v[134:137], v[194:197], v[70:85]
    v_lshl_add_u32 v1, v3, 6, v1
    v_lshl_add_u32 v1, v4, 5, v1
    v_mfma_f32_32x32x16_bf16 v[70:85], v[130:133], v[198:201], v[70:85]
    v_mul_u32_u24 v19, 144, v1
    s_lshl_b32 s11, s10, 5
    v_mfma_f32_32x32x16_bf16 v[70:85], v[126:129], v[202:205], v[70:85]
    v_add_u32 v19, s11, v19
    v_mfma_f32_32x32x16_bf16 v[70:85], v[122:125], v[206:209], v[70:85]
    v_mul_u32_u24 v20, 144, v0
    v_mfma_f32_32x32x16_bf16 v[70:85], v[118:121], v[210:213], v[70:85]
    v_mfma_f32_32x32x16_bf16 v[22:37], v[86:89], v[150:153], v[22:37]
    s_waitcnt lgkmcnt(14)
    s_nop 0
    v_mfma_f32_32x32x16_bf16 v[38:53], v[98:101], v[150:153], v[38:53]
    ds_read_b128 v[118:121], v18 offset:0
    ds_read2_b32 v[182:183], v6 offset0:24 offset1:25
    v_mfma_f32_32x32x16_bf16 v[38:53], v[94:97], v[154:157], v[38:53]
    ds_read2_b32 v[184:185], v6 offset0:26 offset1:27
    ds_read_b128 v[122:125], v18 offset:512
    v_mfma_f32_32x32x16_bf16 v[38:53], v[90:93], v[158:161], v[38:53]
    ds_read2_b32 v[186:187], v7 offset0:24 offset1:25
    ds_read2_b32 v[188:189], v7 offset0:26 offset1:27
    s_waitcnt lgkmcnt(15)
    s_nop 0
    v_mfma_f32_32x32x16_bf16 v[38:53], v[86:89], v[162:165], v[38:53]
    ds_read_b128 v[126:129], v18 offset:1024
    ds_read2_b32 v[190:191], v8 offset0:24 offset1:25
    v_mfma_f32_32x32x16_bf16 v[54:69], v[102:105], v[150:153], v[54:69]
    ds_read2_b32 v[192:193], v8 offset0:26 offset1:27
    ds_read_b128 v[130:133], v18 offset:1536
    v_mfma_f32_32x32x16_bf16 v[54:69], v[98:101], v[154:157], v[54:69]
    ds_read2_b32 v[194:195], v9 offset0:24 offset1:25
    ds_read2_b32 v[196:197], v9 offset0:26 offset1:27
    v_mfma_f32_32x32x16_bf16 v[54:69], v[94:97], v[158:161], v[54:69]
    ds_read_b128 v[134:137], v18 offset:2048
    ds_read2_b32 v[198:199], v10 offset0:24 offset1:25
    v_mfma_f32_32x32x16_bf16 v[54:69], v[90:93], v[162:165], v[54:69]
    ds_read2_b32 v[200:201], v10 offset0:26 offset1:27
    ds_read_b128 v[138:141], v18 offset:2560
    v_mfma_f32_32x32x16_bf16 v[54:69], v[86:89], v[166:169], v[54:69]
    ds_read2_b32 v[202:203], v11 offset0:24 offset1:25
    s_waitcnt lgkmcnt(15)
    s_nop 0
    v_mfma_f32_32x32x16_bf16 v[70:85], v[114:117], v[150:153], v[70:85]
    ds_read2_b32 v[204:205], v11 offset0:26 offset1:27
    v_mfma_f32_32x32x16_bf16 v[70:85], v[110:113], v[154:157], v[70:85]
    ds_read_b128 v[142:145], v18 offset:3072
    v_mfma_f32_32x32x16_bf16 v[70:85], v[106:109], v[158:161], v[70:85]
    ds_read2_b32 v[206:207], v12 offset0:24 offset1:25
    v_mfma_f32_32x32x16_bf16 v[70:85], v[102:105], v[162:165], v[70:85]
    ds_read2_b32 v[208:209], v12 offset0:26 offset1:27
    v_mfma_f32_32x32x16_bf16 v[70:85], v[98:101], v[166:169], v[70:85]
    ds_read_b128 v[146:149], v18 offset:3584
    v_mfma_f32_32x32x16_bf16 v[70:85], v[94:97], v[170:173], v[70:85]
    ds_read2_b32 v[210:211], v13 offset0:24 offset1:25
    v_mfma_f32_32x32x16_bf16 v[70:85], v[90:93], v[174:177], v[70:85]
    ds_read2_b32 v[212:213], v13 offset0:26 offset1:27
    v_mfma_f32_32x32x16_bf16 v[70:85], v[86:89], v[178:181], v[70:85]
    s_waitcnt lgkmcnt(15)
    v_mfma_f32_32x32x16_bf16 v[22:37], v[118:121], v[182:185], v[22:37]
    s_waitcnt lgkmcnt(14)
    v_mfma_f32_32x32x16_bf16 v[38:53], v[130:133], v[182:185], v[38:53]
    v_mfma_f32_32x32x16_bf16 v[38:53], v[126:129], v[186:189], v[38:53]
    v_mfma_f32_32x32x16_bf16 v[38:53], v[122:125], v[190:193], v[38:53]
    s_nop 7
    v_add_f32_dpp v86, v26, v22 row_shr:4 row_mask:0xf bank_mask:0xf bound_ctrl:1
    v_add_f32_dpp v94, v27, v23 row_shr:4 row_mask:0xf bank_mask:0xf bound_ctrl:1
    v_add_f32_dpp v102, v28, v24 row_shr:4 row_mask:0xf bank_mask:0xf bound_ctrl:1
    v_add_f32_dpp v110, v29, v25 row_shr:4 row_mask:0xf bank_mask:0xf bound_ctrl:1
    v_add_f32_dpp v86, v30, v86 row_shr:8 row_mask:0xf bank_mask:0xf bound_ctrl:1
    s_waitcnt lgkmcnt(12)
    v_mfma_f32_32x32x16_bf16 v[38:53], v[118:121], v[194:197], v[38:53]
    v_add_f32_dpp v94, v31, v94 row_shr:8 row_mask:0xf bank_mask:0xf bound_ctrl:1
    v_add_f32_dpp v102, v32, v102 row_shr:8 row_mask:0xf bank_mask:0xf bound_ctrl:1
    v_add_f32_dpp v110, v33, v110 row_shr:8 row_mask:0xf bank_mask:0xf bound_ctrl:1
    v_add_f32_dpp v86, v34, v86 row_shr:12 row_mask:0xf bank_mask:0xf bound_ctrl:1
    v_add_f32_dpp v94, v35, v94 row_shr:12 row_mask:0xf bank_mask:0xf bound_ctrl:1
    s_waitcnt lgkmcnt(11)
    s_nop 0
    v_mfma_f32_32x32x16_bf16 v[54:69], v[134:137], v[182:185], v[54:69]
    v_add_f32_dpp v102, v36, v102 row_shr:12 row_mask:0xf bank_mask:0xf bound_ctrl:1
    v_add_f32_dpp v110, v37, v110 row_shr:12 row_mask:0xf bank_mask:0xf bound_ctrl:1
    v_mov_b32_dpp v87, v34 row_shl:4 row_mask:0xf bank_mask:0xf bound_ctrl:1
    v_mov_b32_dpp v95, v35 row_shl:4 row_mask:0xf bank_mask:0xf bound_ctrl:1
    v_mov_b32_dpp v103, v36 row_shl:4 row_mask:0xf bank_mask:0xf bound_ctrl:1
    v_mfma_f32_32x32x16_bf16 v[54:69], v[130:133], v[186:189], v[54:69]
    v_mov_b32_dpp v111, v37 row_shl:4 row_mask:0xf bank_mask:0xf bound_ctrl:1
    v_add_f32_dpp v87, v30, v87 row_shl:8 row_mask:0xf bank_mask:0xf bound_ctrl:1
    v_add_f32_dpp v95, v31, v95 row_shl:8 row_mask:0xf bank_mask:0xf bound_ctrl:1
    v_add_f32_dpp v103, v32, v103 row_shl:8 row_mask:0xf bank_mask:0xf bound_ctrl:1
    v_add_f32_dpp v111, v33, v111 row_shl:8 row_mask:0xf bank_mask:0xf bound_ctrl:1
    v_mfma_f32_32x32x16_bf16 v[54:69], v[126:129], v[190:193], v[54:69]
    v_add_f32_dpp v87, v26, v87 row_shl:12 row_mask:0xf bank_mask:0xf bound_ctrl:1
    v_add_f32_dpp v95, v27, v95 row_shl:12 row_mask:0xf bank_mask:0xf bound_ctrl:1
    v_add_f32_dpp v103, v28, v103 row_shl:12 row_mask:0xf bank_mask:0xf bound_ctrl:1
    v_add_f32_dpp v111, v29, v111 row_shl:12 row_mask:0xf bank_mask:0xf bound_ctrl:1
    v_add_f32_dpp v88, v42, v38 row_shr:4 row_mask:0xf bank_mask:0xf bound_ctrl:1
    v_mfma_f32_32x32x16_bf16 v[54:69], v[122:125], v[194:197], v[54:69]
    v_add_f32_dpp v96, v43, v39 row_shr:4 row_mask:0xf bank_mask:0xf bound_ctrl:1
    v_add_f32_dpp v104, v44, v40 row_shr:4 row_mask:0xf bank_mask:0xf bound_ctrl:1
    v_add_f32_dpp v112, v45, v41 row_shr:4 row_mask:0xf bank_mask:0xf bound_ctrl:1
    v_add_f32_dpp v88, v46, v88 row_shr:8 row_mask:0xf bank_mask:0xf bound_ctrl:1
    v_add_f32_dpp v96, v47, v96 row_shr:8 row_mask:0xf bank_mask:0xf bound_ctrl:1
    s_waitcnt lgkmcnt(9)
    s_nop 0
    v_mfma_f32_32x32x16_bf16 v[54:69], v[118:121], v[198:201], v[54:69]
    v_add_f32_dpp v104, v48, v104 row_shr:8 row_mask:0xf bank_mask:0xf bound_ctrl:1
    v_add_f32_dpp v112, v49, v112 row_shr:8 row_mask:0xf bank_mask:0xf bound_ctrl:1
    v_add_f32_dpp v88, v50, v88 row_shr:12 row_mask:0xf bank_mask:0xf bound_ctrl:1
    v_add_f32_dpp v96, v51, v96 row_shr:12 row_mask:0xf bank_mask:0xf bound_ctrl:1
    v_add_f32_dpp v104, v52, v104 row_shr:12 row_mask:0xf bank_mask:0xf bound_ctrl:1
    s_waitcnt lgkmcnt(2)
    s_nop 0
    v_mfma_f32_32x32x16_bf16 v[70:85], v[146:149], v[182:185], v[70:85]
    v_add_f32_dpp v112, v53, v112 row_shr:12 row_mask:0xf bank_mask:0xf bound_ctrl:1
    v_mov_b32_dpp v89, v50 row_shl:4 row_mask:0xf bank_mask:0xf bound_ctrl:1
    v_mov_b32_dpp v97, v51 row_shl:4 row_mask:0xf bank_mask:0xf bound_ctrl:1
    v_mov_b32_dpp v105, v52 row_shl:4 row_mask:0xf bank_mask:0xf bound_ctrl:1
    v_mov_b32_dpp v113, v53 row_shl:4 row_mask:0xf bank_mask:0xf bound_ctrl:1
    v_mfma_f32_32x32x16_bf16 v[70:85], v[142:145], v[186:189], v[70:85]
    v_add_f32_dpp v89, v46, v89 row_shl:8 row_mask:0xf bank_mask:0xf bound_ctrl:1
    v_add_f32_dpp v97, v47, v97 row_shl:8 row_mask:0xf bank_mask:0xf bound_ctrl:1
    v_add_f32_dpp v105, v48, v105 row_shl:8 row_mask:0xf bank_mask:0xf bound_ctrl:1
    v_add_f32_dpp v113, v49, v113 row_shl:8 row_mask:0xf bank_mask:0xf bound_ctrl:1
    v_add_f32_dpp v89, v42, v89 row_shl:12 row_mask:0xf bank_mask:0xf bound_ctrl:1
    v_mfma_f32_32x32x16_bf16 v[70:85], v[138:141], v[190:193], v[70:85]
    v_add_f32_dpp v97, v43, v97 row_shl:12 row_mask:0xf bank_mask:0xf bound_ctrl:1
    v_add_f32_dpp v105, v44, v105 row_shl:12 row_mask:0xf bank_mask:0xf bound_ctrl:1
    v_add_f32_dpp v113, v45, v113 row_shl:12 row_mask:0xf bank_mask:0xf bound_ctrl:1
    v_add_f32 v89, v54, v89
    v_add_f32 v97, v55, v97
    v_mfma_f32_32x32x16_bf16 v[70:85], v[134:137], v[194:197], v[70:85]
    v_add_f32 v105, v56, v105
    v_add_f32 v113, v57, v113
    v_add_f32_dpp v89, v58, v89 row_shr:4 row_mask:0xf bank_mask:0xf bound_ctrl:1
    v_add_f32_dpp v97, v59, v97 row_shr:4 row_mask:0xf bank_mask:0xf bound_ctrl:1
    v_add_f32_dpp v105, v60, v105 row_shr:4 row_mask:0xf bank_mask:0xf bound_ctrl:1
    v_mfma_f32_32x32x16_bf16 v[70:85], v[130:133], v[198:201], v[70:85]
    v_add_f32_dpp v113, v61, v113 row_shr:4 row_mask:0xf bank_mask:0xf bound_ctrl:1
    v_add_f32_dpp v89, v62, v89 row_shr:8 row_mask:0xf bank_mask:0xf bound_ctrl:1
    v_add_f32_dpp v97, v63, v97 row_shr:8 row_mask:0xf bank_mask:0xf bound_ctrl:1
    v_add_f32_dpp v105, v64, v105 row_shr:8 row_mask:0xf bank_mask:0xf bound_ctrl:1
    v_add_f32_dpp v113, v65, v113 row_shr:8 row_mask:0xf bank_mask:0xf bound_ctrl:1
    v_mfma_f32_32x32x16_bf16 v[70:85], v[126:129], v[202:205], v[70:85]
    v_add_f32_dpp v89, v66, v89 row_shr:12 row_mask:0xf bank_mask:0xf bound_ctrl:1
    v_add_f32_dpp v97, v67, v97 row_shr:12 row_mask:0xf bank_mask:0xf bound_ctrl:1
    v_add_f32_dpp v105, v68, v105 row_shr:12 row_mask:0xf bank_mask:0xf bound_ctrl:1
    v_add_f32_dpp v113, v69, v113 row_shr:12 row_mask:0xf bank_mask:0xf bound_ctrl:1
    ds_write_b128 v19, v[86:89] offset:27648
    v_mfma_f32_32x32x16_bf16 v[70:85], v[122:125], v[206:209], v[70:85]
    ds_write_b128 v19, v[94:97] offset:28800
    ds_write_b128 v19, v[102:105] offset:29952
    ds_write_b128 v19, v[110:113] offset:31104
    v_mov_b32_dpp v90, v66 row_shl:4 row_mask:0xf bank_mask:0xf bound_ctrl:1
    v_mov_b32_dpp v98, v67 row_shl:4 row_mask:0xf bank_mask:0xf bound_ctrl:1
    s_waitcnt lgkmcnt(4)
    s_nop 0
    v_mfma_f32_32x32x16_bf16 v[70:85], v[118:121], v[210:213], v[70:85]
    v_mov_b32_dpp v106, v68 row_shl:4 row_mask:0xf bank_mask:0xf bound_ctrl:1
    v_mov_b32_dpp v114, v69 row_shl:4 row_mask:0xf bank_mask:0xf bound_ctrl:1
    v_add_f32_dpp v90, v62, v90 row_shl:8 row_mask:0xf bank_mask:0xf bound_ctrl:1
    v_add_f32_dpp v98, v63, v98 row_shl:8 row_mask:0xf bank_mask:0xf bound_ctrl:1
    v_add_f32_dpp v106, v64, v106 row_shl:8 row_mask:0xf bank_mask:0xf bound_ctrl:1
    v_add_f32_dpp v114, v65, v114 row_shl:8 row_mask:0xf bank_mask:0xf bound_ctrl:1
    v_add_f32_dpp v90, v58, v90 row_shl:12 row_mask:0xf bank_mask:0xf bound_ctrl:1
    v_add_f32_dpp v98, v59, v98 row_shl:12 row_mask:0xf bank_mask:0xf bound_ctrl:1
    v_add_f32_dpp v106, v60, v106 row_shl:12 row_mask:0xf bank_mask:0xf bound_ctrl:1
    v_add_f32_dpp v114, v61, v114 row_shl:12 row_mask:0xf bank_mask:0xf bound_ctrl:1
    s_nop 1
    s_nop 0
    v_add_f32_dpp v91, v74, v70 row_shr:4 row_mask:0xf bank_mask:0xf bound_ctrl:1
    v_add_f32_dpp v99, v75, v71 row_shr:4 row_mask:0xf bank_mask:0xf bound_ctrl:1
    v_add_f32_dpp v107, v76, v72 row_shr:4 row_mask:0xf bank_mask:0xf bound_ctrl:1
    v_add_f32_dpp v115, v77, v73 row_shr:4 row_mask:0xf bank_mask:0xf bound_ctrl:1
    v_add_f32_dpp v91, v78, v91 row_shr:8 row_mask:0xf bank_mask:0xf bound_ctrl:1
    v_add_f32_dpp v99, v79, v99 row_shr:8 row_mask:0xf bank_mask:0xf bound_ctrl:1
    v_add_f32_dpp v107, v80, v107 row_shr:8 row_mask:0xf bank_mask:0xf bound_ctrl:1
    v_add_f32_dpp v115, v81, v115 row_shr:8 row_mask:0xf bank_mask:0xf bound_ctrl:1
    v_add_f32_dpp v91, v82, v91 row_shr:12 row_mask:0xf bank_mask:0xf bound_ctrl:1
    v_add_f32_dpp v99, v83, v99 row_shr:12 row_mask:0xf bank_mask:0xf bound_ctrl:1
    v_add_f32_dpp v107, v84, v107 row_shr:12 row_mask:0xf bank_mask:0xf bound_ctrl:1
    v_add_f32_dpp v115, v85, v115 row_shr:12 row_mask:0xf bank_mask:0xf bound_ctrl:1
    ds_write_b64 v19, v[90:91] offset:27664
    ds_write_b64 v19, v[98:99] offset:28816
    ds_write_b64 v19, v[106:107] offset:29968
    ds_write_b64 v19, v[114:115] offset:31120
    s_waitcnt lgkmcnt(0)
    s_branch L_cvj
L_cvb:
    ds_read_b128 v[86:89], v18 offset:64
    ds_read2_b32 v[150:151], v6 offset0:8 offset1:9
    ds_read2_b32 v[152:153], v6 offset0:10 offset1:11
    ds_read_b128 v[90:93], v18 offset:576
    ds_read2_b32 v[154:155], v7 offset0:8 offset1:9
    ds_read2_b32 v[156:157], v7 offset0:10 offset1:11
    ds_read_b128 v[94:97], v18 offset:1088
    ds_read2_b32 v[158:159], v8 offset0:8 offset1:9
    ds_read2_b32 v[160:161], v8 offset0:10 offset1:11
    ds_read_b128 v[98:101], v18 offset:1600
    ds_read2_b32 v[162:163], v9 offset0:8 offset1:9
    ds_read2_b32 v[164:165], v9 offset0:10 offset1:11
    ds_read_b128 v[102:105], v18 offset:2112
    ds_read2_b32 v[166:167], v10 offset0:8 offset1:9
    ds_read2_b32 v[168:169], v10 offset0:10 offset1:11
    s_waitcnt lgkmcnt(11)
    v_mfma_f32_32x32x16_bf16 v[22:37], v[90:93], v[150:153], 0
    s_waitcnt lgkmcnt(9)
    v_mfma_f32_32x32x16_bf16 v[22:37], v[86:89], v[154:157], v[22:37]
    v_mfma_f32_32x32x16_bf16 v[38:53], v[90:93], v[154:157], 0
    ds_read_b128 v[106:109], v18 offset:2624
    ds_read2_b32 v[170:171], v11 offset0:8 offset1:9
    ds_read2_b32 v[172:173], v11 offset0:10 offset1:11
    s_waitcnt lgkmcnt(11)
    v_mfma_f32_32x32x16_bf16 v[38:53], v[94:97], v[150:153], v[38:53]
    s_waitcnt lgkmcnt(9)
    v_mfma_f32_32x32x16_bf16 v[38:53], v[86:89], v[158:161], v[38:53]
    ds_read_b128 v[110:113], v18 offset:3136
    ds_read2_b32 v[174:175], v12 offset0:8 offset1:9
    ds_read2_b32 v[176:177], v12 offset0:10 offset1:11
    s_waitcnt lgkmcnt(11)
    v_mfma_f32_32x32x16_bf16 v[54:69], v[98:101], v[158:161], 0
    ds_read_b128 v[118:121], v18 offset:96
    ds_read_b32 v182, v14 offset:0
    ds_read_b32 v183, v15 offset:0
    s_waitcnt lgkmcnt(12)
    v_mfma_f32_32x32x16_bf16 v[54:69], v[94:97], v[162:165], v[54:69]
    ds_read_b32 v184, v16 offset:0
    ds_read_b32 v185, v17 offset:0
    ds_read_b128 v[122:125], v18 offset:608
    v_mfma_f32_32x32x16_bf16 v[70:85], v[98:101], v[162:165], 0
    ds_read_b32 v186, v14 offset:576
    ds_read_b32 v187, v15 offset:576
    ds_read_b32 v188, v16 offset:576
    s_waitcnt lgkmcnt(15)
    s_nop 0
    v_mfma_f32_32x32x16_bf16 v[54:69], v[102:105], v[154:157], v[54:69]
    ds_read_b32 v189, v17 offset:576
    ds_read_b128 v[126:129], v18 offset:1120
    ds_read_b32 v190, v14 offset:1152
    v_mfma_f32_32x32x16_bf16 v[54:69], v[90:93], v[166:169], v[54:69]
    ds_read_b32 v191, v15 offset:1152
    ds_read_b32 v192, v16 offset:1152
    ds_read_b32 v193, v17 offset:1152
    v_mfma_f32_32x32x16_bf16 v[70:85], v[102:105], v[158:161], v[70:85]
    ds_read_b128 v[130:133], v18 offset:1632
    ds_read_b32 v194, v14 offset:1728
    ds_read_b32 v195, v15 offset:1728
    v_mfma_f32_32x32x16_bf16 v[70:85], v[94:97], v[166:169], v[70:85]
    ds_read_b32 v196, v16 offset:1728
    ds_read_b32 v197, v17 offset:1728
    ds_read_b128 v[134:137], v18 offset:2144
    s_waitcnt lgkmcnt(15)
    s_nop 0
    v_mfma_f32_32x32x16_bf16 v[54:69], v[106:109], v[150:153], v[54:69]
    ds_read_b32 v198, v14 offset:2304
    ds_read_b32 v199, v15 offset:2304
    ds_read_b32 v200, v16 offset:2304
    v_mfma_f32_32x32x16_bf16 v[54:69], v[86:89], v[170:173], v[54:69]
    ds_read_b32 v201, v17 offset:2304
    ds_read_b128 v[138:141], v18 offset:2656
    ds_read_b32 v202, v14 offset:2880
    v_mfma_f32_32x32x16_bf16 v[70:85], v[106:109], v[154:157], v[70:85]
    ds_read_b32 v203, v15 offset:2880
    ds_read_b32 v204, v16 offset:2880
    ds_read_b32 v205, v17 offset:2880
    v_mfma_f32_32x32x16_bf16 v[70:85], v[90:93], v[170:173], v[70:85]
    ds_read_b128 v[142:145], v18 offset:3168
    ds_read_b32 v206, v14 offset:3456
    ds_read_b32 v207, v15 offset:3456
    v_mfma_f32_32x32x16_bf16 v[70:85], v[110:113], v[150:153], v[70:85]
    ds_read_b32 v208, v16 offset:3456
    ds_read_b32 v209, v17 offset:3456
    v_mfma_f32_32x32x16_bf16 v[70:85], v[86:89], v[174:177], v[70:85]
    v_mfma_f32_32x32x16_bf16 v[22:37], v[122:125], v[182:185], v[22:37]
    s_waitcnt lgkmcnt(15)
    s_nop 0
    v_mfma_f32_32x32x16_bf16 v[22:37], v[118:121], v[186:189], v[22:37]
    ds_read_b128 v[86:89], v18 offset:32
    ds_read2_b32 v[150:151], v6 offset0:16 offset1:17
    v_mfma_f32_32x32x16_bf16 v[38:53], v[126:129], v[182:185], v[38:53]
    ds_read2_b32 v[152:153], v6 offset0:18 offset1:19
    ds_read_b128 v[90:93], v18 offset:544
    v_mfma_f32_32x32x16_bf16 v[38:53], v[122:125], v[186:189], v[38:53]
    ds_read2_b32 v[154:155], v7 offset0:16 offset1:17
    ds_read2_b32 v[156:157], v7 offset0:18 offset1:19
    v_mfma_f32_32x32x16_bf16 v[38:53], v[118:121], v[190:193], v[38:53]
    ds_read_b128 v[94:97], v18 offset:1056
    ds_read2_b32 v[158:159], v8 offset0:16 offset1:17
    s_waitcnt lgkmcnt(15)
    s_nop 0
    v_mfma_f32_32x32x16_bf16 v[54:69], v[138:141], v[182:185], v[54:69]
    ds_read2_b32 v[160:161], v8 offset0:18 offset1:19
    ds_read_b128 v[98:101], v18 offset:1568
    v_mfma_f32_32x32x16_bf16 v[54:69], v[134:137], v[186:189], v[54:69]
    ds_read2_b32 v[162:163], v9 offset0:16 offset1:17
    ds_read2_b32 v[164:165], v9 offset0:18 offset1:19
    v_mfma_f32_32x32x16_bf16 v[54:69], v[130:133], v[190:193], v[54:69]
    ds_read_b128 v[102:105], v18 offset:2080
    ds_read2_b32 v[166:167], v10 offset0:16 offset1:17
    v_mfma_f32_32x32x16_bf16 v[54:69], v[126:129], v[194:197], v[54:69]
    ds_read2_b32 v[168:169], v10 offset0:18 offset1:19
    ds_read_b128 v[106:109], v18 offset:2592
    v_mfma_f32_32x32x16_bf16 v[54:69], v[122:125], v[198:201], v[54:69]
    ds_read2_b32 v[170:171], v11 offset0:16 offset1:17
    ds_read2_b32 v[172:173], v11 offset0:18 offset1:19
    s_waitcnt lgkmcnt(15)
    s_nop 0
    v_mfma_f32_32x32x16_bf16 v[54:69], v[118:121], v[202:205], v[54:69]
    ds_read_b128 v[110:113], v18 offset:3104
    ds_read2_b32 v[174:175], v12 offset0:16 offset1:17
    v_mfma_f32_32x32x16_bf16 v[70:85], v[142:145], v[182:185], v[70:85]
    ds_read2_b32 v[176:177], v12 offset0:18 offset1:19
    v_lshl_add_u32 v1, v3, 6, v1
    v_mfma_f32_32x32x16_bf16 v[70:85], v[138:141], v[186:189], v[70:85]
    v_lshl_add_u32 v1, v4, 5, v1
    v_mfma_f32_32x32x16_bf16 v[70:85], v[134:137], v[190:193], v[70:85]
    v_mul_u32_u24 v19, 144, v1
    v_mfma_f32_32x32x16_bf16 v[70:85], v[130:133], v[194:197], v[70:85]
    s_lshl_b32 s11, s10, 5
    v_mfma_f32_32x32x16_bf16 v[70:85], v[126:129], v[198:201], v[70:85]
    v_add_u32 v19, s11, v19
    v_mfma_f32_32x32x16_bf16 v[70:85], v[122:125], v[202:205], v[70:85]
    v_mul_u32_u24 v20, 144, v0
    v_mfma_f32_32x32x16_bf16 v[70:85], v[118:121], v[206:209], v[70:85]
    s_waitcnt lgkmcnt(15)
    v_mfma_f32_32x32x16_bf16 v[22:37], v[90:93], v[150:153], v[22:37]
    v_mfma_f32_32x32x16_bf16 v[22:37], v[86:89], v[154:157], v[22:37]
    ds_read_b128 v[118:121], v18 offset:0
    ds_read2_b32 v[182:183], v6 offset0:24 offset1:25
    s_waitcnt lgkmcnt(15)
    v_mfma_f32_32x32x16_bf16 v[38:53], v[94:97], v[150:153], v[38:53]
    ds_read2_b32 v[184:185], v6 offset0:26 offset1:27
    ds_read_b128 v[122:125], v18 offset:512
    v_mfma_f32_32x32x16_bf16 v[38:53], v[90:93], v[154:157], v[38:53]
    ds_read2_b32 v[186:187], v7 offset0:24 offset1:25
    ds_read2_b32 v[188:189], v7 offset0:26 offset1:27
    s_waitcnt lgkmcnt(15)
    v_mfma_f32_32x32x16_bf16 v[38:53], v[86:89], v[158:161], v[38:53]
    ds_read_b128 v[126:129], v18 offset:1024
    ds_read2_b32 v[190:191], v8 offset0:24 offset1:25
    s_waitcnt lgkmcnt(13)
    v_mfma_f32_32x32x16_bf16 v[54:69], v[106:109], v[150:153], v[54:69]
    ds_read2_b32 v[192:193], v8 offset0:26 offset1:27
    ds_read_b128 v[130:133], v18 offset:1536
    v_mfma_f32_32x32x16_bf16 v[54:69], v[102:105], v[154:157], v[54:69]
    ds_read2_b32 v[194:195], v9 offset0:24 offset1:25
    v_mfma_f32_32x32x16_bf16 v[54:69], v[98:101], v[158:161], v[54:69]
    ds_read2_b32 v[196:197], v9 offset0:26 offset1:27
    v_mfma_f32_32x32x16_bf16 v[54:69], v[94:97], v[162:165], v[54:69]
    ds_read_b128 v[134:137], v18 offset:2048
    v_mfma_f32_32x32x16_bf16 v[54:69], v[90:93], v[166:169], v[54:69]
    ds_read2_b32 v[198:199], v10 offset0:24 offset1:25
    s_waitcnt lgkmcnt(15)
    s_nop 0
    v_mfma_f32_32x32x16_bf16 v[54:69], v[86:89], v[170:173], v[54:69]
    ds_read2_b32 v[200:201], v10 offset0:26 offset1:27
    v_mfma_f32_32x32x16_bf16 v[70:85], v[110:113], v[150:153], v[70:85]
    ds_read_b128 v[138:141], v18 offset:2560
    v_mfma_f32_32x32x16_bf16 v[70:85], v[106:109], v[154:157], v[70:85]
    ds_read2_b32 v[202:203], v11 offset0:24 offset1:25
    v_mfma_f32_32x32x16_bf16 v[70:85], v[102:105], v[158:161], v[70:85]
    ds_read2_b32 v[204:205], v11 offset0:26 offset1:27
    v_mfma_f32_32x32x16_bf16 v[70:85], v[98:101], v[162:165], v[70:85]
    ds_read_b128 v[142:145], v18 offset:3072
    v_mfma_f32_32x32x16_bf16 v[70:85], v[94:97], v[166:169], v[70:85]
    ds_read2_b32 v[206:207], v12 offset0:24 offset1:25
    v_mfma_f32_32x32x16_bf16 v[70:85], v[90:93], v[170:173], v[70:85]
    ds_read2_b32 v[208:209], v12 offset0:26 offset1:27
    s_waitcnt lgkmcnt(15)
    v_mfma_f32_32x32x16_bf16 v[70:85], v[86:89], v[174:177], v[70:85]
    v_mfma_f32_32x32x16_bf16 v[22:37], v[122:125], v[182:185], v[22:37]
    v_mfma_f32_32x32x16_bf16 v[22:37], v[118:121], v[186:189], v[22:37]
    s_waitcnt lgkmcnt(14)
    v_mfma_f32_32x32x16_bf16 v[38:53], v[126:129], v[182:185], v[38:53]
    v_mfma_f32_32x32x16_bf16 v[38:53], v[122:125], v[186:189], v[38:53]
    s_waitcnt lgkmcnt(12)
    v_mfma_f32_32x32x16_bf16 v[38:53], v[118:121], v[190:193], v[38:53]
    s_nop 6
    v_add_f32_dpp v86, v26, v22 row_shr:4 row_mask:0xf bank_mask:0xf bound_ctrl:1
    v_add_f32_dpp v94, v27, v23 row_shr:4 row_mask:0xf bank_mask:0xf bound_ctrl:1
    v_add_f32_dpp v102, v28, v24 row_shr:4 row_mask:0xf bank_mask:0xf bound_ctrl:1
    v_add_f32_dpp v110, v29, v25 row_shr:4 row_mask:0xf bank_mask:0xf bound_ctrl:1
    v_add_f32_dpp v86, v30, v86 row_shr:8 row_mask:0xf bank_mask:0xf bound_ctrl:1
    s_waitcnt lgkmcnt(5)
    s_nop 0
    v_mfma_f32_32x32x16_bf16 v[54:69], v[138:141], v[182:185], v[54:69]
    v_add_f32_dpp v94, v31, v94 row_shr:8 row_mask:0xf bank_mask:0xf bound_ctrl:1
    v_add_f32_dpp v102, v32, v102 row_shr:8 row_mask:0xf bank_mask:0xf bound_ctrl:1
    v_add_f32_dpp v110, v33, v110 row_shr:8 row_mask:0xf bank_mask:0xf bound_ctrl:1
    v_add_f32_dpp v86, v34, v86 row_shr:12 row_mask:0xf bank_mask:0xf bound_ctrl:1
    v_add_f32_dpp v94, v35, v94 row_shr:12 row_mask:0xf bank_mask:0xf bound_ctrl:1
    v_mfma_f32_32x32x16_bf16 v[54:69], v[134:137], v[186:189], v[54:69]
    v_add_f32_dpp v102, v36, v102 row_shr:12 row_mask:0xf bank_mask:0xf bound_ctrl:1
    v_add_f32_dpp v110, v37, v110 row_shr:12 row_mask:0xf bank_mask:0xf bound_ctrl:1
    v_mov_b32_dpp v87, v34 row_shl:4 row_mask:0xf bank_mask:0xf bound_ctrl:1
    v_mov_b32_dpp v95, v35 row_shl:4 row_mask:0xf bank_mask:0xf bound_ctrl:1
    v_mov_b32_dpp v103, v36 row_shl:4 row_mask:0xf bank_mask:0xf bound_ctrl:1
    v_mfma_f32_32x32x16_bf16 v[54:69], v[130:133], v[190:193], v[54:69]
    v_mov_b32_dpp v111, v37 row_shl:4 row_mask:0xf bank_mask:0xf bound_ctrl:1
    v_add_f32_dpp v87, v30, v87 row_shl:8 row_mask:0xf bank_mask:0xf bound_ctrl:1
    v_add_f32_dpp v95, v31, v95 row_shl:8 row_mask:0xf bank_mask:0xf bound_ctrl:1
    v_add_f32_dpp v103, v32, v103 row_shl:8 row_mask:0xf bank_mask:0xf bound_ctrl:1
    v_add_f32_dpp v111, v33, v111 row_shl:8 row_mask:0xf bank_mask:0xf bound_ctrl:1
    v_mfma_f32_32x32x16_bf16 v[54:69], v[126:129], v[194:197], v[54:69]
    v_add_f32_dpp v87, v26, v87 row_shl:12 row_mask:0xf bank_mask:0xf bound_ctrl:1
    v_add_f32_dpp v95, v27, v95 row_shl:12 row_mask:0xf bank_mask:0xf bound_ctrl:1
    v_add_f32_dpp v103, v28, v103 row_shl:12 row_mask:0xf bank_mask:0xf bound_ctrl:1
    v_add_f32_dpp v111, v29, v111 row_shl:12 row_mask:0xf bank_mask:0xf bound_ctrl:1
    v_add_f32_e64 v87, v38, v87
    v_mfma_f32_32x32x16_bf16 v[54:69], v[122:125], v[198:201], v[54:69]
    v_add_f32 v95, v39, v95
    v_add_f32 v103, v40, v103
    v_add_f32_e64 v111, v41, v111
    v_add_f32_dpp v87, v42, v87 row_shr:4 row_mask:0xf bank_mask:0xf bound_ctrl:1
    v_add_f32_dpp v95, v43, v95 row_shr:4 row_mask:0xf bank_mask:0xf bound_ctrl:1
    s_waitcnt lgkmcnt(3)
    s_nop 0
    v_mfma_f32_32x32x16_bf16 v[54:69], v[118:121], v[202:205], v[54:69]
    v_add_f32_dpp v103, v44, v103 row_shr:4 row_mask:0xf bank_mask:0xf bound_ctrl:1
    v_add_f32_dpp v111, v45, v111 row_shr:4 row_mask:0xf bank_mask:0xf bound_ctrl:1
    v_add_f32_dpp v87, v46, v87 row_shr:8 row_mask:0xf bank_mask:0xf bound_ctrl:1
    v_add_f32_dpp v95, v47, v95 row_shr:8 row_mask:0xf bank_mask:0xf bound_ctrl:1
    v_add_f32_dpp v103, v48, v103 row_shr:8 row_mask:0xf bank_mask:0xf bound_ctrl:1
    s_waitcnt lgkmcnt(2)
    s_nop 0
    v_mfma_f32_32x32x16_bf16 v[70:85], v[142:145], v[182:185], v[70:85]
    v_add_f32_dpp v111, v49, v111 row_shr:8 row_mask:0xf bank_mask:0xf bound_ctrl:1
    v_add_f32_dpp v87, v50, v87 row_shr:12 row_mask:0xf bank_mask:0xf bound_ctrl:1
    v_add_f32_dpp v95, v51, v95 row_shr:12 row_mask:0xf bank_mask:0xf bound_ctrl:1
    v_add_f32_dpp v103, v52, v103 row_shr:12 row_mask:0xf bank_mask:0xf bound_ctrl:1
    v_add_f32_dpp v111, v53, v111 row_shr:12 row_mask:0xf bank_mask:0xf bound_ctrl:1
    v_mfma_f32_32x32x16_bf16 v[70:85], v[138:141], v[186:189], v[70:85]
    v_mov_b32_dpp v88, v50 row_shl:4 row_mask:0xf bank_mask:0xf bound_ctrl:1
    v_mov_b32_dpp v96, v51 row_shl:4 row_mask:0xf bank_mask:0xf bound_ctrl:1
    v_mov_b32_dpp v104, v52 row_shl:4 row_mask:0xf bank_mask:0xf bound_ctrl:1
    v_mov_b32_dpp v112, v53 row_shl:4 row_mask:0xf bank_mask:0xf bound_ctrl:1
    v_add_f32_dpp v88, v46, v88 row_shl:8 row_mask:0xf bank_mask:0xf bound_ctrl:1
    v_mfma_f32_32x32x16_bf16 v[70:85], v[134:137], v[190:193], v[70:85]
    v_add_f32_dpp v96, v47, v96 row_shl:8 row_mask:0xf bank_mask:0xf bound_ctrl:1
    v_add_f32_dpp v104, v48, v104 row_shl:8 row_mask:0xf bank_mask:0xf bound_ctrl:1
    v_add_f32_dpp v112, v49, v112 row_shl:8 row_mask:0xf bank_mask:0xf bound_ctrl:1
    v_add_f32_dpp v88, v42, v88 row_shl:12 row_mask:0xf bank_mask:0xf bound_ctrl:1
    v_add_f32_dpp v96, v43, v96 row_shl:12 row_mask:0xf bank_mask:0xf bound_ctrl:1
    v_mfma_f32_32x32x16_bf16 v[70:85], v[130:133], v[194:197], v[70:85]
    v_add_f32_dpp v104, v44, v104 row_shl:12 row_mask:0xf bank_mask:0xf bound_ctrl:1
    v_add_f32_dpp v112, v45, v112 row_shl:12 row_mask:0xf bank_mask:0xf bound_ctrl:1
    v_add_f32_dpp v89, v58, v54 row_shr:4 row_mask:0xf bank_mask:0xf bound_ctrl:1
    v_add_f32_dpp v97, v59, v55 row_shr:4 row_mask:0xf bank_mask:0xf bound_ctrl:1
    v_add_f32_dpp v105, v60, v56 row_shr:4 row_mask:0xf bank_mask:0xf bound_ctrl:1
    v_mfma_f32_32x32x16_bf16 v[70:85], v[126:129], v[198:201], v[70:85]
    v_add_f32_dpp v113, v61, v57 row_shr:4 row_mask:0xf bank_mask:0xf bound_ctrl:1
    v_add_f32_dpp v89, v62, v89 row_shr:8 row_mask:0xf bank_mask:0xf bound_ctrl:1
    v_add_f32_dpp v97, v63, v97 row_shr:8 row_mask:0xf bank_mask:0xf bound_ctrl:1
    v_add_f32_dpp v105, v64, v105 row_shr:8 row_mask:0xf bank_mask:0xf bound_ctrl:1
    v_add_f32_dpp v113, v65, v113 row_shr:8 row_mask:0xf bank_mask:0xf bound_ctrl:1
    v_mfma_f32_32x32x16_bf16 v[70:85], v[122:125], v[202:205], v[70:85]
    v_add_f32_dpp v89, v66, v89 row_shr:12 row_mask:0xf bank_mask:0xf bound_ctrl:1
    v_add_f32_dpp v97, v67, v97 row_shr:12 row_mask:0xf bank_mask:0xf bound_ctrl:1
    v_add_f32_dpp v105, v68, v105 row_shr:12 row_mask:0xf bank_mask:0xf bound_ctrl:1
    v_add_f32_dpp v113, v69, v113 row_shr:12 row_mask:0xf bank_mask:0xf bound_ctrl:1
    ds_write_b128 v19, v[86:89] offset:27648
    s_waitcnt lgkmcnt(1)
    s_nop 0
    v_mfma_f32_32x32x16_bf16 v[70:85], v[118:121], v[206:209], v[70:85]
    ds_write_b128 v19, v[94:97] offset:28800
    ds_write_b128 v19, v[102:105] offset:29952
    ds_write_b128 v19, v[110:113] offset:31104
    v_mov_b32_dpp v90, v66 row_shl:4 row_mask:0xf bank_mask:0xf bound_ctrl:1
    v_mov_b32_dpp v98, v67 row_shl:4 row_mask:0xf bank_mask:0xf bound_ctrl:1
    v_mov_b32_dpp v106, v68 row_shl:4 row_mask:0xf bank_mask:0xf bound_ctrl:1
    v_mov_b32_dpp v114, v69 row_shl:4 row_mask:0xf bank_mask:0xf bound_ctrl:1
    v_add_f32_dpp v90, v62, v90 row_shl:8 row_mask:0xf bank_mask:0xf bound_ctrl:1
    v_add_f32_dpp v98, v63, v98 row_shl:8 row_mask:0xf bank_mask:0xf bound_ctrl:1
    v_add_f32_dpp v106, v64, v106 row_shl:8 row_mask:0xf bank_mask:0xf bound_ctrl:1
    v_add_f32_dpp v114, v65, v114 row_shl:8 row_mask:0xf bank_mask:0xf bound_ctrl:1
    v_add_f32_dpp v90, v58, v90 row_shl:12 row_mask:0xf bank_mask:0xf bound_ctrl:1
    v_add_f32_dpp v98, v59, v98 row_shl:12 row_mask:0xf bank_mask:0xf bound_ctrl:1
    v_add_f32_dpp v106, v60, v106 row_shl:12 row_mask:0xf bank_mask:0xf bound_ctrl:1
    v_add_f32_dpp v114, v61, v114 row_shl:12 row_mask:0xf bank_mask:0xf bound_ctrl:1
    v_add_f32 v90, v70, v90
    v_add_f32 v98, v71, v98
    v_add_f32 v106, v72, v106
    v_add_f32 v114, v73, v114
    v_add_f32_dpp v90, v74, v90 row_shr:4 row_mask:0xf bank_mask:0xf bound_ctrl:1
    v_add_f32_dpp v98, v75, v98 row_shr:4 row_mask:0xf bank_mask:0xf bound_ctrl:1
    v_add_f32_dpp v106, v76, v106 row_shr:4 row_mask:0xf bank_mask:0xf bound_ctrl:1
    v_add_f32_dpp v114, v77, v114 row_shr:4 row_mask:0xf bank_mask:0xf bound_ctrl:1
    v_add_f32_dpp v90, v78, v90 row_shr:8 row_mask:0xf bank_mask:0xf bound_ctrl:1
    v_add_f32_dpp v98, v79, v98 row_shr:8 row_mask:0xf bank_mask:0xf bound_ctrl:1
    v_add_f32_dpp v106, v80, v106 row_shr:8 row_mask:0xf bank_mask:0xf bound_ctrl:1
    v_add_f32_dpp v114, v81, v114 row_shr:8 row_mask:0xf bank_mask:0xf bound_ctrl:1
    v_add_f32_dpp v90, v82, v90 row_shr:12 row_mask:0xf bank_mask:0xf bound_ctrl:1
    v_add_f32_dpp v98, v83, v98 row_shr:12 row_mask:0xf bank_mask:0xf bound_ctrl:1
    v_add_f32_dpp v106, v84, v106 row_shr:12 row_mask:0xf bank_mask:0xf bound_ctrl:1
    v_add_f32_dpp v114, v85, v114 row_shr:12 row_mask:0xf bank_mask:0xf bound_ctrl:1
    v_mov_b32_dpp v91, v82 row_shl:4 row_mask:0xf bank_mask:0xf bound_ctrl:1
    v_mov_b32_dpp v99, v83 row_shl:4 row_mask:0xf bank_mask:0xf bound_ctrl:1
    v_mov_b32_dpp v107, v84 row_shl:4 row_mask:0xf bank_mask:0xf bound_ctrl:1
    v_mov_b32_dpp v115, v85 row_shl:4 row_mask:0xf bank_mask:0xf bound_ctrl:1
    v_add_f32_dpp v91, v78, v91 row_shl:8 row_mask:0xf bank_mask:0xf bound_ctrl:1
    v_add_f32_dpp v99, v79, v99 row_shl:8 row_mask:0xf bank_mask:0xf bound_ctrl:1
    v_add_f32_dpp v107, v80, v107 row_shl:8 row_mask:0xf bank_mask:0xf bound_ctrl:1
    v_add_f32_dpp v115, v81, v115 row_shl:8 row_mask:0xf bank_mask:0xf bound_ctrl:1
    v_add_f32_dpp v91, v74, v91 row_shl:12 row_mask:0xf bank_mask:0xf bound_ctrl:1
    v_add_f32_dpp v99, v75, v99 row_shl:12 row_mask:0xf bank_mask:0xf bound_ctrl:1
    v_add_f32_dpp v107, v76, v107 row_shl:12 row_mask:0xf bank_mask:0xf bound_ctrl:1
    v_add_f32_dpp v115, v77, v115 row_shl:12 row_mask:0xf bank_mask:0xf bound_ctrl:1
    ds_write_b64 v19, v[90:91] offset:27664
    ds_write_b64 v19, v[98:99] offset:28816
    ds_write_b64 v19, v[106:107] offset:29968
    ds_write_b64 v19, v[114:115] offset:31120
    s_waitcnt lgkmcnt(0)
L_cvj:
    s_barrier
    s_setprio 3
    s_nop 0
    ds_read_b128 v[22:25], v20 offset:27648
    ds_read_b64 v[26:27], v20 offset:27664
    ds_read_b128 v[28:31], v20 offset:27680
    ds_read_b64 v[32:33], v20 offset:27696
    ds_read_b128 v[34:37], v20 offset:27712
    ds_read_b64 v[38:39], v20 offset:27728
    ds_read_b128 v[40:43], v20 offset:27744
    ds_read_b64 v[44:45], v20 offset:27760
    s_mul_i32 s11, s8, 12416
    s_add_u32 s36, s11, 9109504
    s_add_u32 s37, s36, 4096
    s_add_u32 s38, s36, 8192
    s_add_u32 s39, s36, 12288
    v_mov_b32 v49, v5
    v_mov_b32 v53, v5
    v_mov_b32 v57, v5
    v_mov_b32 v56, 0
    s_waitcnt lgkmcnt(5)
    v_add_f32 v28, v28, v23
    v_add_f32 v24, v24, v30
    v_add_f32 v31, v31, v26
    s_waitcnt lgkmcnt(4)
    v_add_f32 v27, v27, v33
    s_waitcnt lgkmcnt(1)
    v_add_f32 v40, v40, v35
    v_add_f32 v36, v36, v42
    v_add_f32 v43, v43, v38
    s_waitcnt lgkmcnt(0)
    v_add_f32 v39, v39, v45
    v_mul_u32_u24_e64 v3, 48, v0
    v_cvt_pk_bf16_f32 v46, v22, v34
    v_cvt_pk_bf16_f32 v47, v28, v40
    v_cvt_pk_bf16_f32 v48, v29, v41
    ds_write_b128 v3, v[46:49] offset:8448
    v_cvt_pk_bf16_f32 v50, v24, v36
    v_cvt_pk_bf16_f32 v51, v25, v37
    v_cvt_pk_bf16_f32 v52, v31, v43
    ds_write_b128 v3, v[50:53] offset:8464
    v_cvt_pk_bf16_f32 v54, v32, v44
    v_cvt_pk_bf16_f32 v55, v27, v39
    ds_write_b128 v3, v[54:57] offset:8480
    s_waitcnt lgkmcnt(0)
    s_barrier
    ds_read_b128 v[46:49], v21 offset:8448
    ds_read_b128 v[50:53], v21 offset:12544
    ds_read_b128 v[54:57], v21 offset:16640
    s_waitcnt lgkmcnt(2)
    buffer_store_dwordx4 v[46:49], v21, s[4:7], s36 offen sc1
    s_waitcnt lgkmcnt(1)
    buffer_store_dwordx4 v[50:53], v21, s[4:7], s37 offen sc1
    s_waitcnt lgkmcnt(0)
    buffer_store_dwordx4 v[54:57], v21, s[4:7], s38 offen sc1
    s_waitcnt vmcnt(0)
    s_cmp_lg_u32 s10, 3
    s_cbranch_scc1 L_hs13
    s_mul_i32 s11, s8, 12416
    s_add_u32 s11, s11, 9121792
    s_mov_b64 exec, 1
    v_mov_b32 v3, 0
    buffer_store_dword v5, v3, s[4:7], s11 offen sc1
    s_mov_b64 exec, -1
L_hs13:
L_end:
    s_endpgm
L_rty12:
    s_mov_b32 s13, 0
L_chk10:
    s_sleep 2
    buffer_load_dwordx4 v[62:65], v22, s[4:7], s36 offen offset:0 sc1
    buffer_load_dwordx4 v[66:69], v22, s[4:7], s36 offen offset:128 sc1
    buffer_load_dwordx4 v[70:73], v23, s[4:7], s36 offen offset:256 sc1
    s_add_u32 s13, s13, 1
    s_waitcnt vmcnt(0)
    v_xor_b32 v2, v5, v65
    v_xor_b32 v69, v5, v69
    v_xor_b32_e64 v73, v5, v73
    v_or3_b32 v2, v2, v69, v73
    v_cmpx_ne_u32 vcc, 0, v2
    s_nop 0
    s_cbranch_execz L_chk10x
    s_cmp_lt_u32 s13, 20000
    s_cbranch_scc1 L_chk10
L_chk10x:
    s_branch L_got11
L_codeend:
.section .rodata,"a"
.p2align 6
.amdhsa_kernel gated_mix__ssm_conv_s4__spectral_gfnet__prompt_kernel
  .amdhsa_next_free_vgpr 256
  .amdhsa_next_free_sgpr 72
  .amdhsa_accum_offset 256
  .amdhsa_group_segment_fixed_size 0
  .amdhsa_kernarg_size 128
  .amdhsa_user_sgpr_count 2
  .amdhsa_user_sgpr_kernarg_segment_ptr 1
  .amdhsa_system_sgpr_workgroup_id_x 1
.end_amdhsa_kernel
```
